```python
import torch

def _softmax(x, axis=-1):
    return torch.softmax(x, dim=axis)
def _gelu(x):
    return torch.nn.functional.gelu(x, approximate="tanh")
def _silu(x):
    return torch.nn.functional.silu(x)
def _sigmoid(x):
    return torch.sigmoid(x)
def _layernorm(x, axis=-1, eps=1e-5):
    m = x.mean(dim=axis, keepdim=True)
    v = x.var(dim=axis, keepdim=True, unbiased=False)
    return (x - m) / torch.sqrt(v + eps)
def _scatter_add(tgt, idx, src, axis=0):
    return tgt.clone().index_add_(axis, idx, src)
def _segment_sum(src, seg, n):
    out = torch.zeros((n,) + src.shape[1:], dtype=src.dtype)
    return out.index_add_(0, seg, src)
def _pad(x, pw):
    flat = tuple(v for pair in reversed(pw) for v in pair)
    return torch.nn.functional.pad(x, flat)

kernel_name = 'sequential_preLN__ssm_conv_s4d__glu_gated_glu__prompt'

def setup_inputs():

    _w = (lambda a: (lambda t: t.to(torch.bfloat16) if t.is_floating_point() else t)(torch.as_tensor(a)))
    def _A_setup():
        Bsz, L, D, N = 1, 2048, 512, 128
        return {
            "u": _w((lambda *s: torch.randn(*s, dtype=torch.bfloat16) * 0.05)(Bsz, L, D)),
            "log_A_real": _w((lambda *s: torch.randn(*s, dtype=torch.bfloat16) * 6.4)(D, N) * 0.5),
            "A_imag": _w((lambda *s: torch.randn(*s, dtype=torch.bfloat16) * 0.05)(D, N) * 3.14),
            "C_real": _w((lambda *s: torch.randn(*s, dtype=torch.bfloat16) * 0.05)(D, N) / N ** 0.5),
            "C_imag": _w((lambda *s: torch.randn(*s, dtype=torch.bfloat16) * 0.05)(D, N) / N ** 0.5),
            "log_dt": _w((lambda *s: torch.randn(*s, dtype=torch.bfloat16) * 0.05)(D) * 0.5 - 4.0),
            "D_skip": _w((lambda *s: torch.randn(*s, dtype=torch.bfloat16) * 0.05)(D)),
        }
    _A_in = _A_setup()

    def _B_setup():
        B, S, D, F = 1, 2048, 512, 1792
        return {
            "x": _w((lambda *s: torch.randn(*s, dtype=torch.bfloat16) * 0.05)(B, S, D)),
            "w_gate": _w((lambda *s: torch.randn(*s, dtype=torch.bfloat16) * 0.05)(D, F)),
            "w_up": _w((lambda *s: torch.randn(*s, dtype=torch.bfloat16) * 0.05)(D, F)),
            "w_down": _w((lambda *s: torch.randn(*s, dtype=torch.bfloat16) * 0.05)(F, D)),
        }
    _B_in = _B_setup()

    return {
        "A_u": _A_in["u"],
        "A_log_A_real": _A_in["log_A_real"],
        "A_A_imag": _A_in["A_imag"],
        "A_C_real": _A_in["C_real"],
        "A_C_imag": _A_in["C_imag"],
        "A_log_dt": _A_in["log_dt"],
        "A_D_skip": _A_in["D_skip"],
        "B_x": _B_in["x"],
        "B_w_gate": _B_in["w_gate"],
        "B_w_up": _B_in["w_up"],
        "B_w_down": _B_in["w_down"],
    }

def reference(A_u, A_log_A_real, A_A_imag, A_C_real, A_C_imag, A_log_dt, A_D_skip, B_x, B_w_gate, B_w_up, B_w_down):
    def _A_ref(u, log_A_real, A_imag, C_real, C_imag, log_dt, D_skip):
        L = u.shape[1]
        dt = torch.exp(log_dt)
        A = -torch.exp(log_A_real) + 1j * A_imag
        C = (C_real + 1j * C_imag) * dt[:, None]
        pos = (lambda x, dt: x.to(dt))(torch.arange(L), log_dt.dtype)
        P = torch.exp((A * dt[:, None])[:, :, None] * pos[None, None, :])
        K = 2.0 * torch.einsum("dn,dnl->dl", C, P).real
        L2 = 2 * L
        u_t = (lambda x, *d: x.permute(*d))(u, 0, 2, 1)
        Kf = (lambda x, *a, **k: torch.fft.rfft(x.float(), *a, **k))(K, L2)
        Uf = (lambda x, *a, **k: torch.fft.rfft(x.float(), *a, **k))(u_t, L2)
        y = (lambda x, *a, **k: torch.fft.irfft(x, *a, **k).to(torch.bfloat16))(Uf * Kf[None, :, :], L2)[:, :, :L]
        y = (lambda x, *d: x.permute(*d))(y, 0, 2, 1)
        return y + u * D_skip[None, None, :]

    def _B_ref(x, w_gate, w_up, w_down):
        g = torch.einsum("bsd,df->bsf", x, w_gate)
        u = torch.einsum("bsd,df->bsf", x, w_up)
        h = _sigmoid(g) * u
        return torch.einsum("bsf,fd->bsd", h, w_down)

    x = A_u
    h = x + _A_ref(_layernorm(x, axis=-1), A_log_A_real, A_A_imag, A_C_real, A_C_imag, A_log_dt, A_D_skip)
    h2 = h + _B_ref(_layernorm(h, axis=-1), B_w_gate, B_w_up, B_w_down)
    return h2
```

```asm
; @launch grid=(256,1,1) block=(512,1,1) lds=163840
.amdgcn_target "amdgcn-amd-amdhsa--gfx950"
.text
.globl sequential_preLN__ssm_conv_s4d__glu_gated_glu__prompt_kernel
.p2align 8
.type sequential_preLN__ssm_conv_s4d__glu_gated_glu__prompt_kernel,@function
sequential_preLN__ssm_conv_s4d__glu_gated_glu__prompt_kernel:
L_begin:
    s_cmp_ge_u32 s2, 256
    s_cbranch_scc1 L_end
    s_load_dwordx16 s[36:51], s[0:1], 0
    s_load_dwordx8 s[12:19], s[0:1], 64
    s_load_dwordx2 s[20:21], s[0:1], 104
    v_lshrrev_b32 v1, 6, v0
    v_and_b32 v2, 63, v0
    v_lshlrev_b32 v7, 4, v2
    v_readfirstlane_b32 s3, v1
    v_and_b32 v3, 255, v0
    s_lshl_b32 s24, s2, 9
    v_lshl_add_u32 v4, v3, 1, s24
    v_mov_b32 v5, 0
    s_lshl_b32 s22, s2, 2
    s_and_b32 s65, s3, 3
    s_lshr_b32 s25, s3, 2
    s_lshl_b32 s26, s25, 4
    s_bfe_u32 s66, s3, 0x10001
    s_mov_b32 s6, 0x10000000
    s_mov_b32 s7, 0x20000
    s_mov_b32 s23, 0x1430000
    s_cmp_ge_u32 s3, 4
    s_cbranch_scc1 L_help
    s_lshl_b32 s29, s2, 13
    s_lshl_b32 s30, s3, 11
    s_add_u32 s29, s29, s30
    s_mov_b32 s10, 0x200000
    s_mov_b32 s11, 0x20000
    s_waitcnt lgkmcnt(0)
    s_mov_b32 s8, s36
    s_mov_b32 s9, s37
    s_mov_b32 s4, s20
    s_mov_b32 s5, s21
    buffer_load_dwordx4 v[12:15], v7, s[8:11], s29 offen
    buffer_load_dwordx4 v[16:19], v7, s[8:11], s29 offen offset:1024
    global_load_ushort v8, v4, s[38:39]
    global_load_ushort v9, v4, s[40:41]
    buffer_load_dword v10, v5, s[4:7], s23 offen sc1
    s_load_dword s27, s[46:47], s22
    s_load_dword s28, s[48:49], s22
    v_mov_b32 v24, 0
    v_mov_b32 v25, 0
    v_mov_b32 v26, 0
    v_mov_b32 v27, 0
    s_mul_i32 s29, s3, 4640
    s_add_u32 s29, s29, 72320
    v_add_u32 v28, s29, v7
    s_mul_i32 s29, s65, 4224
    s_add_u32 s29, s29, 109440
    v_add_u32 v29, s29, v7
    s_mov_b64 exec, 0xffffff
    ds_write_b128 v28, v[24:27]
    s_mov_b64 exec, 0x7f
    ds_write_b128 v29, v[24:27]
    s_mov_b64 exec, -1
    s_mul_i32 s29, s66, 16896
    s_mul_i32 s31, s25, 33792
    s_add_u32 s29, s29, s31
    s_and_b32 s31, s3, 1
    s_lshl_b32 s31, s31, 8
    s_add_u32 s29, s29, s31
    v_lshlrev_b32 v30, 2, v2
    v_add_u32 v30, s29, v30
    s_mul_i32 s29, s25, 18560
    s_add_u32 s29, s29, 72704
    v_and_b32 v3, 255, v0
    v_lshlrev_b32 v69, 4, v3
    v_add_u32 v68, s29, v69
    s_lshl_b32 s29, s25, 12
    s_add_u32 s29, s29, 126336
    v_add_u32 v69, s29, v69
    v_lshlrev_b32 v70, 6, v3
    v_subrev_u32 v71, 64, v70
    s_lshl_b32 s23, s2, 14
    s_add_u32 s32, s20, s23
    s_addc_u32 s33, s21, 0
    s_mov_b32 s34, 16384
    s_mov_b32 s35, 0x20000
    s_and_b32 s61, s2, 1
    s_lshl_b32 s61, s61, 3
    s_bfe_u32 s23, s2, 0x30003
    s_add_u32 s61, s61, s23
    s_bfe_u32 s62, s2, 0x20001
    s_lshl_b32 s62, s62, 2
    s_lshr_b32 s23, s2, 6
    s_add_u32 s62, s62, s23
    s_and_b32 s63, s2, 7
    s_lshl_b32 s63, s63, 2
    s_bfe_u32 s23, s2, 0x20003
    s_add_u32 s63, s63, s23
    s_lshr_b32 s64, s2, 5
    s_mul_i32 s67, s64, 112
    s_mul_i32 s23, s65, 28
    s_mul_i32 s29, s25, 10
    s_add_u32 s23, s23, s29
    s_add_u32 s67, s67, s23
    s_lshl_b32 s67, s67, 11
    s_add_u32 s67, s67, 16777216
    s_mul_i32 s68, s63, 224
    s_add_u32 s68, s68, s23
    s_lshl_b32 s68, s68, 10
    s_add_u32 s68, s68, 8388608
    s_lshl_b32 s24, s3, 2
    s_add_u32 s24, s24, 160768
    v_mov_b32 v1, s24
    ds_write_b32 v1, v24
    v_mov_b32 v1, 0x3b000000
    s_mul_i32 s24, s3, 4224
    s_add_u32 s24, s24, 126336
    v_lshlrev_b32 v4, 5, v2
    v_add_u32 v4, s24, v4
    v_bfe_u32 v5, v2, 2, 2
    v_mul_u32_u24 v5, 2112, v5
    v_lshrrev_b32 v6, 4, v2
    v_lshl_add_u32 v5, v6, 5, v5
    v_and_b32 v6, 3, v2
    v_lshl_add_u32 v5, v6, 3, v5
    s_lshl_b32 s24, s3, 9
    s_add_u32 s24, s24, 126336
    v_add_u32 v5, s24, v5
    v_lshrrev_b32 v11, 2, v2
    v_lshlrev_b32 v11, 14, v11
    v_lshl_add_u32 v11, v6, 4, v11
    s_lshl_b32 s24, s3, 20
    s_lshl_b32 s29, s2, 6
    s_add_u32 s24, s24, s29
    s_waitcnt vmcnt(4)
    v_lshlrev_b32 v36, 16, v12
    v_and_b32 v37, 0xffff0000, v12
    v_lshlrev_b32 v38, 16, v13
    v_and_b32 v39, 0xffff0000, v13
    v_lshlrev_b32 v40, 16, v14
    v_and_b32 v41, 0xffff0000, v14
    v_lshlrev_b32 v42, 16, v15
    v_and_b32 v43, 0xffff0000, v15
    v_add_f32 v20, v36, v37
    v_mul_f32 v21, v36, v36
    v_fmac_f32 v21, v37, v37
    v_add_f32 v20, v20, v38
    v_fmac_f32 v21, v38, v38
    v_add_f32 v20, v20, v39
    v_fmac_f32 v21, v39, v39
    v_add_f32 v20, v20, v40
    v_fmac_f32 v21, v40, v40
    v_add_f32 v20, v20, v41
    v_fmac_f32 v21, v41, v41
    v_add_f32 v20, v20, v42
    v_fmac_f32 v21, v42, v42
    v_add_f32 v20, v20, v43
    v_fmac_f32 v21, v43, v43
    s_waitcnt vmcnt(3)
    v_lshlrev_b32 v44, 16, v16
    v_and_b32 v45, 0xffff0000, v16
    v_lshlrev_b32 v46, 16, v17
    v_and_b32 v47, 0xffff0000, v17
    v_lshlrev_b32 v48, 16, v18
    v_and_b32 v49, 0xffff0000, v18
    v_lshlrev_b32 v50, 16, v19
    v_and_b32 v51, 0xffff0000, v19
    v_add_f32 v22, v44, v45
    v_mul_f32 v23, v44, v44
    v_fmac_f32 v23, v45, v45
    v_add_f32 v22, v22, v46
    v_fmac_f32 v23, v46, v46
    v_add_f32 v22, v22, v47
    v_fmac_f32 v23, v47, v47
    v_add_f32 v22, v22, v48
    v_fmac_f32 v23, v48, v48
    v_add_f32 v22, v22, v49
    v_fmac_f32 v23, v49, v49
    v_add_f32 v22, v22, v50
    v_fmac_f32 v23, v50, v50
    v_add_f32 v22, v22, v51
    v_fmac_f32 v23, v51, v51
    v_add_f32_dpp v20, v20, v20 row_shr:1 row_mask:0xf bank_mask:0xf bound_ctrl:1
    v_add_f32_dpp v21, v21, v21 row_shr:1 row_mask:0xf bank_mask:0xf bound_ctrl:1
    v_add_f32_dpp v22, v22, v22 row_shr:1 row_mask:0xf bank_mask:0xf bound_ctrl:1
    v_add_f32_dpp v23, v23, v23 row_shr:1 row_mask:0xf bank_mask:0xf bound_ctrl:1
    v_add_f32_dpp v20, v20, v20 row_shr:2 row_mask:0xf bank_mask:0xf bound_ctrl:1
    v_add_f32_dpp v21, v21, v21 row_shr:2 row_mask:0xf bank_mask:0xf bound_ctrl:1
    v_add_f32_dpp v22, v22, v22 row_shr:2 row_mask:0xf bank_mask:0xf bound_ctrl:1
    v_add_f32_dpp v23, v23, v23 row_shr:2 row_mask:0xf bank_mask:0xf bound_ctrl:1
    v_add_f32_dpp v20, v20, v20 row_shr:4 row_mask:0xf bank_mask:0xf bound_ctrl:1
    v_add_f32_dpp v21, v21, v21 row_shr:4 row_mask:0xf bank_mask:0xf bound_ctrl:1
    v_add_f32_dpp v22, v22, v22 row_shr:4 row_mask:0xf bank_mask:0xf bound_ctrl:1
    v_add_f32_dpp v23, v23, v23 row_shr:4 row_mask:0xf bank_mask:0xf bound_ctrl:1
    v_add_f32_dpp v20, v20, v20 row_shr:8 row_mask:0xf bank_mask:0xf bound_ctrl:1
    v_add_f32_dpp v21, v21, v21 row_shr:8 row_mask:0xf bank_mask:0xf bound_ctrl:1
    v_add_f32_dpp v22, v22, v22 row_shr:8 row_mask:0xf bank_mask:0xf bound_ctrl:1
    v_add_f32_dpp v23, v23, v23 row_shr:8 row_mask:0xf bank_mask:0xf bound_ctrl:1
    v_add_f32_dpp v20, v20, v20 row_bcast:15 row_mask:0xa bank_mask:0xf
    v_add_f32_dpp v21, v21, v21 row_bcast:15 row_mask:0xa bank_mask:0xf
    v_add_f32_dpp v22, v22, v22 row_bcast:15 row_mask:0xa bank_mask:0xf
    v_add_f32_dpp v23, v23, v23 row_bcast:15 row_mask:0xa bank_mask:0xf
    v_add_f32_dpp v20, v20, v20 row_bcast:31 row_mask:0xc bank_mask:0xf
    v_add_f32_dpp v21, v21, v21 row_bcast:31 row_mask:0xc bank_mask:0xf
    v_add_f32_dpp v22, v22, v22 row_bcast:31 row_mask:0xc bank_mask:0xf
    v_add_f32_dpp v23, v23, v23 row_bcast:31 row_mask:0xc bank_mask:0xf
    v_readlane_b32 s52, v20, 63
    v_readlane_b32 s53, v21, 63
    v_readlane_b32 s54, v22, 63
    v_readlane_b32 s55, v23, 63
    v_mul_f32 v24, s52, v1
    v_mul_f32 v25, s53, v1
    v_fma_f32 v25, -v24, v24, v25
    v_max_f32 v25, 0, v25
    v_cvt_pk_bf16_f32 v26, v24, v25
    v_lshlrev_b32 v24, 16, v26
    v_and_b32 v25, 0xffff0000, v26
    v_add_f32 v25, 0x3727c5ac, v25
    v_cvt_pk_bf16_f32 v25, v25, v25
    v_and_b32 v25, 0xffff0000, v25
    v_sqrt_f32 v25, v25
    s_nop 0
    v_cvt_pk_bf16_f32 v25, v25, v25
    v_and_b32 v25, 0xffff0000, v25
    v_rcp_f32 v25, v25
    v_mul_f32 v27, s54, v1
    v_mul_f32 v28, s55, v1
    v_fma_f32 v28, -v27, v27, v28
    v_max_f32 v28, 0, v28
    v_cvt_pk_bf16_f32 v29, v27, v28
    v_lshlrev_b32 v27, 16, v29
    v_and_b32 v28, 0xffff0000, v29
    v_add_f32 v28, 0x3727c5ac, v28
    v_cvt_pk_bf16_f32 v28, v28, v28
    v_and_b32 v28, 0xffff0000, v28
    v_sqrt_f32 v28, v28
    s_nop 0
    v_cvt_pk_bf16_f32 v28, v28, v28
    v_and_b32 v28, 0xffff0000, v28
    v_rcp_f32 v28, v28
    v_sub_f32 v36, v36, v24
    v_sub_f32 v37, v37, v24
    v_sub_f32 v38, v38, v24
    v_sub_f32 v39, v39, v24
    v_sub_f32 v40, v40, v24
    v_sub_f32 v41, v41, v24
    v_sub_f32 v42, v42, v24
    v_sub_f32 v43, v43, v24
    v_cvt_pk_bf16_f32 v52, v36, v37
    v_cvt_pk_bf16_f32 v54, v38, v39
    v_cvt_pk_bf16_f32 v56, v40, v41
    v_cvt_pk_bf16_f32 v58, v42, v43
    v_lshlrev_b32 v36, 16, v52
    v_and_b32 v37, 0xffff0000, v52
    v_lshlrev_b32 v38, 16, v54
    v_and_b32 v39, 0xffff0000, v54
    v_lshlrev_b32 v40, 16, v56
    v_and_b32 v41, 0xffff0000, v56
    v_lshlrev_b32 v42, 16, v58
    v_and_b32 v43, 0xffff0000, v58
    v_mul_f32 v36, v36, v25
    v_mul_f32 v37, v37, v25
    v_mul_f32 v38, v38, v25
    v_mul_f32 v39, v39, v25
    v_mul_f32 v40, v40, v25
    v_mul_f32 v41, v41, v25
    v_mul_f32 v42, v42, v25
    v_mul_f32 v43, v43, v25
    v_cvt_pk_bf16_f32 v52, v36, v37
    v_mov_b32 v53, v12
    v_cvt_pk_bf16_f32 v54, v38, v39
    v_mov_b32 v55, v13
    v_cvt_pk_bf16_f32 v56, v40, v41
    v_mov_b32 v57, v14
    v_cvt_pk_bf16_f32 v58, v42, v43
    v_mov_b32 v59, v15
    ds_write_b128 v4, v[52:55] offset:0
    ds_write_b128 v4, v[56:59] offset:16
    v_sub_f32 v44, v44, v27
    v_sub_f32 v45, v45, v27
    v_sub_f32 v46, v46, v27
    v_sub_f32 v47, v47, v27
    v_sub_f32 v48, v48, v27
    v_sub_f32 v49, v49, v27
    v_sub_f32 v50, v50, v27
    v_sub_f32 v51, v51, v27
    v_cvt_pk_bf16_f32 v60, v44, v45
    v_cvt_pk_bf16_f32 v62, v46, v47
    v_cvt_pk_bf16_f32 v64, v48, v49
    v_cvt_pk_bf16_f32 v66, v50, v51
    v_lshlrev_b32 v44, 16, v60
    v_and_b32 v45, 0xffff0000, v60
    v_lshlrev_b32 v46, 16, v62
    v_and_b32 v47, 0xffff0000, v62
    v_lshlrev_b32 v48, 16, v64
    v_and_b32 v49, 0xffff0000, v64
    v_lshlrev_b32 v50, 16, v66
    v_and_b32 v51, 0xffff0000, v66
    v_mul_f32 v44, v44, v28
    v_mul_f32 v45, v45, v28
    v_mul_f32 v46, v46, v28
    v_mul_f32 v47, v47, v28
    v_mul_f32 v48, v48, v28
    v_mul_f32 v49, v49, v28
    v_mul_f32 v50, v50, v28
    v_mul_f32 v51, v51, v28
    v_cvt_pk_bf16_f32 v60, v44, v45
    v_mov_b32 v61, v16
    v_cvt_pk_bf16_f32 v62, v46, v47
    v_mov_b32 v63, v17
    v_cvt_pk_bf16_f32 v64, v48, v49
    v_mov_b32 v65, v18
    v_cvt_pk_bf16_f32 v66, v50, v51
    v_mov_b32 v67, v19
    ds_write_b128 v4, v[60:63] offset:2112
    ds_write_b128 v4, v[64:67] offset:2128
    s_waitcnt lgkmcnt(0)
    s_barrier
    ds_read_b64_tr_b16 v[12:13], v5 offset:0
    ds_read_b64_tr_b16 v[14:15], v5 offset:8448
    ds_read_b64_tr_b16 v[16:17], v5 offset:128
    ds_read_b64_tr_b16 v[18:19], v5 offset:8576
    ds_read_b64_tr_b16 v[20:21], v5 offset:256
    ds_read_b64_tr_b16 v[22:23], v5 offset:8704
    ds_read_b64_tr_b16 v[24:25], v5 offset:384
    ds_read_b64_tr_b16 v[26:27], v5 offset:8832
    s_waitcnt lgkmcnt(6)
    buffer_store_dwordx4 v[12:15], v11, s[4:7], s24 offen sc1
    s_add_u32 s24, s24, 262144
    s_waitcnt lgkmcnt(4)
    buffer_store_dwordx4 v[16:19], v11, s[4:7], s24 offen sc1
    s_add_u32 s24, s24, 262144
    s_waitcnt lgkmcnt(2)
    buffer_store_dwordx4 v[20:23], v11, s[4:7], s24 offen sc1
    s_add_u32 s24, s24, 262144
    s_waitcnt lgkmcnt(0)
    buffer_store_dwordx4 v[24:27], v11, s[4:7], s24 offen sc1
    s_waitcnt vmcnt(4)
    v_readfirstlane_b32 s60, v10
    s_lshl_b32 s29, s66, 4
    s_lshr_b32 s27, s27, s29
    s_lshl_b32 s27, s27, 16
    s_lshr_b32 s28, s28, s26
    s_lshl_b32 s28, s28, 16
    v_mov_b32 v33, 0x3fb8aa3b
    v_mul_f32 v34, s27, v33
    v_exp_f32 v34, v34
    v_lshlrev_b32 v8, 16, v8
    v_lshlrev_b32 v9, 16, v9
    v_cvt_pk_bf16_f32 v34, v34, v34
    v_and_b32 v34, 0xffff0000, v34
    v_mul_f32 v8, v8, v33
    v_exp_f32 v8, v8
    v_mul_f32 v9, v9, v34
    v_cvt_pk_bf16_f32 v8, v8, v8
    v_and_b32 v8, 0xffff0000, v8
    v_mul_f32 v8, v8, v34
    v_mul_f32 v9, 0x3e22f983, v9
    v_mul_f32 v8, 0xbfb8aa3b, v8
    s_mul_i32 s60, s60, 1664525
    s_add_u32 s60, s60, 1013904223
    v_mul_f32 v42, 0x41000000, v8
    v_mul_f32 v43, 0x41000000, v9
    v_exp_f32 v42, v42
    v_fract_f32 v43, v43
    v_cos_f32 v36, v43
    v_sin_f32 v37, v43
    v_mul_f32 v36, v36, v42
    v_mul_f32 v37, v37, v42
    v_mov_b32 v44, 0x00003f80
    ds_write_b32 v30, v44
    v_cvt_pk_bf16_f32 v45, v36, v37
    ds_write_b32 v30, v45 offset:528
    v_pk_mul_f32 v[42:43], v[36:37], v[36:37] op_sel_hi:[0,1]
    v_pk_fma_f32 v[38:39], v[36:37], v[36:37], v[42:43] op_sel:[1,1,0] op_sel_hi:[1,0,1] neg_lo:[0,1,0]
    v_cvt_pk_bf16_f32 v46, v38, v39
    ds_write_b32 v30, v46 offset:1056
    v_pk_mul_f32 v[42:43], v[38:39], v[36:37] op_sel_hi:[0,1]
    v_pk_fma_f32 v[40:41], v[38:39], v[36:37], v[42:43] op_sel:[1,1,0] op_sel_hi:[1,0,1] neg_lo:[0,1,0]
    v_cvt_pk_bf16_f32 v47, v40, v41
    ds_write_b32 v30, v47 offset:1584
    v_pk_mul_f32 v[42:43], v[40:41], v[36:37] op_sel_hi:[0,1]
    v_pk_fma_f32 v[38:39], v[40:41], v[36:37], v[42:43] op_sel:[1,1,0] op_sel_hi:[1,0,1] neg_lo:[0,1,0]
    v_cvt_pk_bf16_f32 v44, v38, v39
    ds_write_b32 v30, v44 offset:2112
    v_pk_mul_f32 v[42:43], v[38:39], v[36:37] op_sel_hi:[0,1]
    v_pk_fma_f32 v[40:41], v[38:39], v[36:37], v[42:43] op_sel:[1,1,0] op_sel_hi:[1,0,1] neg_lo:[0,1,0]
    v_cvt_pk_bf16_f32 v45, v40, v41
    ds_write_b32 v30, v45 offset:2640
    v_pk_mul_f32 v[42:43], v[40:41], v[36:37] op_sel_hi:[0,1]
    v_pk_fma_f32 v[38:39], v[40:41], v[36:37], v[42:43] op_sel:[1,1,0] op_sel_hi:[1,0,1] neg_lo:[0,1,0]
    v_cvt_pk_bf16_f32 v46, v38, v39
    ds_write_b32 v30, v46 offset:3168
    v_pk_mul_f32 v[42:43], v[38:39], v[36:37] op_sel_hi:[0,1]
    v_pk_fma_f32 v[40:41], v[38:39], v[36:37], v[42:43] op_sel:[1,1,0] op_sel_hi:[1,0,1] neg_lo:[0,1,0]
    v_cvt_pk_bf16_f32 v47, v40, v41
    ds_write_b32 v30, v47 offset:3696
    v_pk_mul_f32 v[42:43], v[40:41], v[36:37] op_sel_hi:[0,1]
    v_pk_fma_f32 v[38:39], v[40:41], v[36:37], v[42:43] op_sel:[1,1,0] op_sel_hi:[1,0,1] neg_lo:[0,1,0]
    v_cvt_pk_bf16_f32 v44, v38, v39
    ds_write_b32 v30, v44 offset:4224
    v_pk_mul_f32 v[42:43], v[38:39], v[36:37] op_sel_hi:[0,1]
    v_pk_fma_f32 v[40:41], v[38:39], v[36:37], v[42:43] op_sel:[1,1,0] op_sel_hi:[1,0,1] neg_lo:[0,1,0]
    v_cvt_pk_bf16_f32 v45, v40, v41
    ds_write_b32 v30, v45 offset:4752
    v_pk_mul_f32 v[42:43], v[40:41], v[36:37] op_sel_hi:[0,1]
    v_pk_fma_f32 v[38:39], v[40:41], v[36:37], v[42:43] op_sel:[1,1,0] op_sel_hi:[1,0,1] neg_lo:[0,1,0]
    v_cvt_pk_bf16_f32 v46, v38, v39
    ds_write_b32 v30, v46 offset:5280
    v_pk_mul_f32 v[42:43], v[38:39], v[36:37] op_sel_hi:[0,1]
    v_pk_fma_f32 v[40:41], v[38:39], v[36:37], v[42:43] op_sel:[1,1,0] op_sel_hi:[1,0,1] neg_lo:[0,1,0]
    v_cvt_pk_bf16_f32 v47, v40, v41
    ds_write_b32 v30, v47 offset:5808
    v_pk_mul_f32 v[42:43], v[40:41], v[36:37] op_sel_hi:[0,1]
    v_pk_fma_f32 v[38:39], v[40:41], v[36:37], v[42:43] op_sel:[1,1,0] op_sel_hi:[1,0,1] neg_lo:[0,1,0]
    v_cvt_pk_bf16_f32 v44, v38, v39
    ds_write_b32 v30, v44 offset:6336
    v_pk_mul_f32 v[42:43], v[38:39], v[36:37] op_sel_hi:[0,1]
    v_pk_fma_f32 v[40:41], v[38:39], v[36:37], v[42:43] op_sel:[1,1,0] op_sel_hi:[1,0,1] neg_lo:[0,1,0]
    v_cvt_pk_bf16_f32 v45, v40, v41
    ds_write_b32 v30, v45 offset:6864
    v_pk_mul_f32 v[42:43], v[40:41], v[36:37] op_sel_hi:[0,1]
    v_pk_fma_f32 v[38:39], v[40:41], v[36:37], v[42:43] op_sel:[1,1,0] op_sel_hi:[1,0,1] neg_lo:[0,1,0]
    v_cvt_pk_bf16_f32 v46, v38, v39
    ds_write_b32 v30, v46 offset:7392
    v_pk_mul_f32 v[42:43], v[38:39], v[36:37] op_sel_hi:[0,1]
    v_pk_fma_f32 v[40:41], v[38:39], v[36:37], v[42:43] op_sel:[1,1,0] op_sel_hi:[1,0,1] neg_lo:[0,1,0]
    v_cvt_pk_bf16_f32 v47, v40, v41
    ds_write_b32 v30, v47 offset:7920
    v_pk_mul_f32 v[42:43], v[40:41], v[36:37] op_sel_hi:[0,1]
    v_pk_fma_f32 v[38:39], v[40:41], v[36:37], v[42:43] op_sel:[1,1,0] op_sel_hi:[1,0,1] neg_lo:[0,1,0]
    v_cvt_pk_bf16_f32 v44, v38, v39
    ds_write_b32 v30, v44 offset:8448
    v_pk_mul_f32 v[42:43], v[38:39], v[36:37] op_sel_hi:[0,1]
    v_pk_fma_f32 v[40:41], v[38:39], v[36:37], v[42:43] op_sel:[1,1,0] op_sel_hi:[1,0,1] neg_lo:[0,1,0]
    v_cvt_pk_bf16_f32 v45, v40, v41
    ds_write_b32 v30, v45 offset:8976
    v_pk_mul_f32 v[42:43], v[40:41], v[36:37] op_sel_hi:[0,1]
    v_pk_fma_f32 v[38:39], v[40:41], v[36:37], v[42:43] op_sel:[1,1,0] op_sel_hi:[1,0,1] neg_lo:[0,1,0]
    v_cvt_pk_bf16_f32 v46, v38, v39
    ds_write_b32 v30, v46 offset:9504
    v_pk_mul_f32 v[42:43], v[38:39], v[36:37] op_sel_hi:[0,1]
    v_pk_fma_f32 v[40:41], v[38:39], v[36:37], v[42:43] op_sel:[1,1,0] op_sel_hi:[1,0,1] neg_lo:[0,1,0]
    v_cvt_pk_bf16_f32 v47, v40, v41
    ds_write_b32 v30, v47 offset:10032
    v_pk_mul_f32 v[42:43], v[40:41], v[36:37] op_sel_hi:[0,1]
    v_pk_fma_f32 v[38:39], v[40:41], v[36:37], v[42:43] op_sel:[1,1,0] op_sel_hi:[1,0,1] neg_lo:[0,1,0]
    v_cvt_pk_bf16_f32 v44, v38, v39
    ds_write_b32 v30, v44 offset:10560
    v_pk_mul_f32 v[42:43], v[38:39], v[36:37] op_sel_hi:[0,1]
    v_pk_fma_f32 v[40:41], v[38:39], v[36:37], v[42:43] op_sel:[1,1,0] op_sel_hi:[1,0,1] neg_lo:[0,1,0]
    v_cvt_pk_bf16_f32 v45, v40, v41
    ds_write_b32 v30, v45 offset:11088
    v_pk_mul_f32 v[42:43], v[40:41], v[36:37] op_sel_hi:[0,1]
    v_pk_fma_f32 v[38:39], v[40:41], v[36:37], v[42:43] op_sel:[1,1,0] op_sel_hi:[1,0,1] neg_lo:[0,1,0]
    v_cvt_pk_bf16_f32 v46, v38, v39
    ds_write_b32 v30, v46 offset:11616
    v_pk_mul_f32 v[42:43], v[38:39], v[36:37] op_sel_hi:[0,1]
    v_pk_fma_f32 v[40:41], v[38:39], v[36:37], v[42:43] op_sel:[1,1,0] op_sel_hi:[1,0,1] neg_lo:[0,1,0]
    v_cvt_pk_bf16_f32 v47, v40, v41
    ds_write_b32 v30, v47 offset:12144
    v_pk_mul_f32 v[42:43], v[40:41], v[36:37] op_sel_hi:[0,1]
    v_pk_fma_f32 v[38:39], v[40:41], v[36:37], v[42:43] op_sel:[1,1,0] op_sel_hi:[1,0,1] neg_lo:[0,1,0]
    v_cvt_pk_bf16_f32 v44, v38, v39
    ds_write_b32 v30, v44 offset:12672
    v_pk_mul_f32 v[42:43], v[38:39], v[36:37] op_sel_hi:[0,1]
    v_pk_fma_f32 v[40:41], v[38:39], v[36:37], v[42:43] op_sel:[1,1,0] op_sel_hi:[1,0,1] neg_lo:[0,1,0]
    v_cvt_pk_bf16_f32 v45, v40, v41
    ds_write_b32 v30, v45 offset:13200
    v_pk_mul_f32 v[42:43], v[40:41], v[36:37] op_sel_hi:[0,1]
    v_pk_fma_f32 v[38:39], v[40:41], v[36:37], v[42:43] op_sel:[1,1,0] op_sel_hi:[1,0,1] neg_lo:[0,1,0]
    v_cvt_pk_bf16_f32 v46, v38, v39
    ds_write_b32 v30, v46 offset:13728
    v_pk_mul_f32 v[42:43], v[38:39], v[36:37] op_sel_hi:[0,1]
    v_pk_fma_f32 v[40:41], v[38:39], v[36:37], v[42:43] op_sel:[1,1,0] op_sel_hi:[1,0,1] neg_lo:[0,1,0]
    v_cvt_pk_bf16_f32 v47, v40, v41
    ds_write_b32 v30, v47 offset:14256
    v_pk_mul_f32 v[42:43], v[40:41], v[36:37] op_sel_hi:[0,1]
    v_pk_fma_f32 v[38:39], v[40:41], v[36:37], v[42:43] op_sel:[1,1,0] op_sel_hi:[1,0,1] neg_lo:[0,1,0]
    v_cvt_pk_bf16_f32 v44, v38, v39
    ds_write_b32 v30, v44 offset:14784
    v_pk_mul_f32 v[42:43], v[38:39], v[36:37] op_sel_hi:[0,1]
    v_pk_fma_f32 v[40:41], v[38:39], v[36:37], v[42:43] op_sel:[1,1,0] op_sel_hi:[1,0,1] neg_lo:[0,1,0]
    v_cvt_pk_bf16_f32 v45, v40, v41
    ds_write_b32 v30, v45 offset:15312
    v_pk_mul_f32 v[42:43], v[40:41], v[36:37] op_sel_hi:[0,1]
    v_pk_fma_f32 v[38:39], v[40:41], v[36:37], v[42:43] op_sel:[1,1,0] op_sel_hi:[1,0,1] neg_lo:[0,1,0]
    v_cvt_pk_bf16_f32 v46, v38, v39
    ds_write_b32 v30, v46 offset:15840
    v_pk_mul_f32 v[42:43], v[38:39], v[36:37] op_sel_hi:[0,1]
    v_pk_fma_f32 v[40:41], v[38:39], v[36:37], v[42:43] op_sel:[1,1,0] op_sel_hi:[1,0,1] neg_lo:[0,1,0]
    v_cvt_pk_bf16_f32 v47, v40, v41
    ds_write_b32 v30, v47 offset:16368
    v_and_b32 v4, 31, v2
    v_mul_u32_u24 v4, 528, v4
    v_lshrrev_b32 v5, 5, v2
    v_lshl_add_u32 v4, v5, 4, v4
    s_mul_i32 s29, s66, 16896
    v_add_u32 v4, s29, v4
    s_waitcnt vmcnt(0) lgkmcnt(0)
    s_barrier
    ds_read_b128 v[112:115], v4 offset:33792
    ds_read_b128 v[116:119], v4 offset:0
    ds_read_b128 v[120:123], v4 offset:33824
    ds_read_b128 v[124:127], v4 offset:32
    ds_read_b128 v[128:131], v4 offset:33856
    ds_read_b128 v[132:135], v4 offset:64
    ds_read_b128 v[136:139], v4 offset:33888
    ds_read_b128 v[140:143], v4 offset:96
    ds_read_b128 v[144:147], v4 offset:33920
    ds_read_b128 v[148:151], v4 offset:128
    s_mul_i32 s29, s3, 4224
    s_add_u32 s29, s29, 109552
    v_add_u32 v5, s29, v7
    v_and_b32 v8, 1, v2
    v_mul_u32_u24 v8, 4224, v8
    v_bfe_u32 v9, v2, 1, 3
    v_lshrrev_b32 v10, 4, v2
    v_sub_u32 v9, v9, v10
    v_add_u32 v9, 3, v9
    v_lshl_add_u32 v8, v9, 4, v8
    s_mul_i32 s29, s66, 8448
    s_and_b32 s69, s3, 1
    s_lshl_b32 s56, s69, 8
    s_add_u32 s29, s29, s56
    s_add_u32 s29, s29, 109440
    v_add_u32 v8, s29, v8
    v_and_b32 v9, 3, v2
    v_mul_u32_u24 v11, 4640, v9
    v_bfe_u32 v12, v2, 2, 2
    v_lshl_add_u32 v13, v12, 3, v10
    v_lshl_add_u32 v11, v13, 4, v11
    s_mul_i32 s29, s66, 18560
    s_sub_u32 s29, s29, s56
    s_add_u32 s29, s29, 72576
    v_add_u32 v11, s29, v11
    v_lshlrev_b32 v13, 5, v10
    v_lshl_add_u32 v13, v9, 2, v13
    v_lshl_add_u32 v13, v12, 7, v13
    v_and_b32 v14, 1, v2
    v_cmp_eq_u32 s[58:59], 1, v14
    ds_read_b128 v[152:155], v4 offset:33952
    ds_read_b128 v[156:159], v4 offset:160
    s_waitcnt lgkmcnt(10)
    v_mfma_f32_32x32x16_bf16 v[16:31], v[112:115], v[116:119], 0
    ds_read_b128 v[112:115], v4 offset:33984
    ds_read_b128 v[116:119], v4 offset:192
    s_waitcnt lgkmcnt(10)
    v_mfma_f32_32x32x16_bf16 v[16:31], v[120:123], v[124:127], v[16:31]
    ds_read_b128 v[120:123], v4 offset:34016
    ds_read_b128 v[124:127], v4 offset:224
    s_waitcnt lgkmcnt(10)
    v_mfma_f32_32x32x16_bf16 v[16:31], v[128:131], v[132:135], v[16:31]
    ds_read_b128 v[128:131], v4 offset:34048
    ds_read_b128 v[132:135], v4 offset:256
    s_waitcnt lgkmcnt(10)
    v_mfma_f32_32x32x16_bf16 v[16:31], v[136:139], v[140:143], v[16:31]
    ds_read_b128 v[136:139], v4 offset:34080
    ds_read_b128 v[140:143], v4 offset:288
    s_waitcnt lgkmcnt(10)
    v_mfma_f32_32x32x16_bf16 v[16:31], v[144:147], v[148:151], v[16:31]
    ds_read_b128 v[144:147], v4 offset:34112
    ds_read_b128 v[148:151], v4 offset:320
    s_waitcnt lgkmcnt(10)
    v_mfma_f32_32x32x16_bf16 v[16:31], v[152:155], v[156:159], v[16:31]
    ds_read_b128 v[152:155], v4 offset:34144
    ds_read_b128 v[156:159], v4 offset:352
    s_waitcnt lgkmcnt(10)
    v_mfma_f32_32x32x16_bf16 v[16:31], v[112:115], v[116:119], v[16:31]
    ds_read_b128 v[112:115], v4 offset:34176
    ds_read_b128 v[116:119], v4 offset:384
    s_waitcnt lgkmcnt(10)
    v_mfma_f32_32x32x16_bf16 v[16:31], v[120:123], v[124:127], v[16:31]
    ds_read_b128 v[120:123], v4 offset:34208
    ds_read_b128 v[124:127], v4 offset:416
    s_waitcnt lgkmcnt(10)
    v_mfma_f32_32x32x16_bf16 v[16:31], v[128:131], v[132:135], v[16:31]
    ds_read_b128 v[128:131], v4 offset:34240
    ds_read_b128 v[132:135], v4 offset:448
    s_waitcnt lgkmcnt(10)
    v_mfma_f32_32x32x16_bf16 v[16:31], v[136:139], v[140:143], v[16:31]
    ds_read_b128 v[136:139], v4 offset:34272
    ds_read_b128 v[140:143], v4 offset:480
    s_waitcnt lgkmcnt(10)
    v_mfma_f32_32x32x16_bf16 v[16:31], v[144:147], v[148:151], v[16:31]
    s_waitcnt lgkmcnt(8)
    v_mfma_f32_32x32x16_bf16 v[16:31], v[152:155], v[156:159], v[16:31]
    s_waitcnt lgkmcnt(6)
    v_mfma_f32_32x32x16_bf16 v[16:31], v[112:115], v[116:119], v[16:31]
    s_waitcnt lgkmcnt(4)
    v_mfma_f32_32x32x16_bf16 v[16:31], v[120:123], v[124:127], v[16:31]
    s_waitcnt lgkmcnt(2)
    v_mfma_f32_32x32x16_bf16 v[16:31], v[128:131], v[132:135], v[16:31]
    s_waitcnt lgkmcnt(0)
    v_mfma_f32_32x32x16_bf16 v[16:31], v[136:139], v[140:143], v[16:31]
    s_nop 11
    v_cndmask_b32 v48, v27, v28, s[58:59]
    v_cndmask_b32 v49, v29, v30, s[58:59]
    s_cmp_eq_u32 s69, 0
    s_cbranch_scc1 L2_a0
    v_cvt_pk_bf16_f32 v32, v23, v22
    v_cvt_pk_bf16_f32 v33, v21, v20
    v_cvt_pk_bf16_f32 v34, v19, v18
    v_cvt_pk_bf16_f32 v35, v17, v16
    ds_write_b128 v5, v[32:35] offset:0
    v_cvt_pk_bf16_f32 v36, v26, v26
    v_cvt_pk_bf16_f32 v37, v25, v25
    v_cvt_pk_bf16_f32 v38, v25, v24
    v_cvt_pk_bf16_f32 v39, v24, v24
    ds_write_b128 v5, v[36:39] offset:1024
    v_cvt_pk_bf16_f32 v40, v28, v28
    v_cvt_pk_bf16_f32 v41, v28, v48
    v_cvt_pk_bf16_f32 v42, v27, v27
    v_mov_b32 v43, v42
    ds_write_b128 v5, v[40:43] offset:2048
    v_cvt_pk_bf16_f32 v44, v30, v30
    v_cvt_pk_bf16_f32 v45, v30, v49
    v_cvt_pk_bf16_f32 v46, v29, v29
    v_mov_b32 v47, v46
    ds_write_b128 v5, v[44:47] offset:3072
    s_branch L2_conv
L2_a0:
    v_mov_b32 v50, 0
    s_nop 1
    v_mov_b32_dpp v50, v23 wave_shr:1 row_mask:0xf bank_mask:0xf bound_ctrl:1
    v_cvt_pk_bf16_f32 v36, v26, v25
    v_cvt_pk_bf16_f32 v37, v25, v25
    v_cvt_pk_bf16_f32 v38, v24, v24
    v_mov_b32 v39, v38
    ds_write_b128 v5, v[36:39] offset:1024
    v_cvt_pk_bf16_f32 v40, v28, v28
    v_cvt_pk_bf16_f32 v41, v48, v27
    v_cvt_pk_bf16_f32 v42, v27, v27
    v_mov_b32 v43, v42
    ds_write_b128 v5, v[40:43] offset:2048
    v_cvt_pk_bf16_f32 v44, v30, v30
    v_cvt_pk_bf16_f32 v45, v49, v29
    v_cvt_pk_bf16_f32 v46, v29, v29
    v_mov_b32 v47, v46
    ds_write_b128 v5, v[44:47] offset:3072
    v_cvt_pk_bf16_f32 v32, v22, v21
    v_cvt_pk_bf16_f32 v33, v20, v19
    v_cvt_pk_bf16_f32 v34, v18, v17
    v_cvt_pk_bf16_f32 v35, v16, v50
    ds_write_b128 v5, v[32:35] offset:0
L2_conv:
    v_lshlrev_b32 v3, 6, v2
    s_mov_b32 s29, 0x1400000
    s_cmp_lg_u32 s3, 0
    s_cbranch_scc1 L_p1x
    s_mov_b32 s31, 0
L_p1:
    buffer_load_dword v52, v3, s[4:7], s29 offen sc1
    s_add_u32 s30, s29, 4096
    buffer_load_dword v53, v3, s[4:7], s30 offen sc1
    s_add_u32 s30, s29, 8192
    buffer_load_dword v54, v3, s[4:7], s30 offen sc1
    s_add_u32 s30, s29, 12288
    buffer_load_dword v55, v3, s[4:7], s30 offen sc1
    s_add_u32 s31, s31, 1
    s_waitcnt vmcnt(0)
    v_xor_b32 v52, s60, v52
    v_xor_b32 v53, s60, v53
    v_xor_b32 v54, s60, v54
    v_xor_b32 v55, s60, v55
    v_or_b32 v52, v52, v53
    v_or_b32 v52, v52, v54
    v_or_b32 v52, v52, v55
    v_cmp_ne_u32 vcc, 0, v52
    s_cmp_gt_u32 s31, 4000
    s_cbranch_scc1 L_p1x
    s_cbranch_vccz L_p1x
    s_sleep 2
    s_branch L_p1
L_p1x:
    s_waitcnt lgkmcnt(0)
    s_barrier
    buffer_load_dwordx4 v[56:59], v71, s[32:35], s26 offen sc1
    buffer_load_dwordx4 v[60:63], v70, s[32:35], s26 offen sc1
    buffer_load_dwordx4 v[64:67], v70, s[32:35], s26 offen offset:32 sc1
    ds_read_b128 v[112:115], v8 offset:0
    ds_read_b128 v[116:119], v8 offset:512
    ds_read_b128 v[120:123], v8 offset:1024
    ds_read_b128 v[124:127], v8 offset:1536
    ds_read_b128 v[128:131], v8 offset:2048
    ds_read_b128 v[132:135], v8 offset:2560
    ds_read_b128 v[136:139], v8 offset:3072
    ds_read_b128 v[140:143], v8 offset:3584
    s_waitcnt vmcnt(1)
    v_mov_b32 v36, v57
    v_mov_b32 v37, v58
    v_mov_b32 v38, v59
    v_mov_b32 v39, v60
    v_mov_b32 v40, v61
    v_mov_b32 v41, v62
    ds_write_b128 v68, v[58:61] offset:4640
    ds_write_b128 v68, v[60:63] offset:13920
    ds_write_b128 v68, v[36:39]
    ds_write_b128 v68, v[38:41] offset:9280
    v_lshlrev_b32 v44, 16, v60
    v_and_b32 v45, 0xffff0000, v60
    v_lshlrev_b32 v46, 16, v61
    v_and_b32 v47, 0xffff0000, v61
    v_lshlrev_b32 v48, 16, v62
    v_and_b32 v49, 0xffff0000, v62
    v_lshlrev_b32 v50, 16, v63
    v_and_b32 v51, 0xffff0000, v63
    v_mul_f32 v44, s28, v44
    v_mul_f32 v45, s28, v45
    v_mul_f32 v46, s28, v46
    v_mul_f32 v47, s28, v47
    v_mul_f32 v48, s28, v48
    v_mul_f32 v49, s28, v49
    v_mul_f32 v50, s28, v50
    v_mul_f32 v51, s28, v51
    v_cvt_pk_bf16_f32 v52, v44, v45
    v_cvt_pk_bf16_f32 v53, v46, v47
    v_cvt_pk_bf16_f32 v54, v48, v49
    v_cvt_pk_bf16_f32 v55, v50, v51
    ds_write_b128 v69, v[52:55] offset:8192
    s_waitcnt vmcnt(0)
    ds_write_b128 v69, v[64:67]
    s_waitcnt lgkmcnt(0)
    s_barrier
    s_setprio 1
    ds_read_b128 v[144:147], v11 offset:192
    ds_read_b128 v[148:151], v11 offset:704
    ds_read_b128 v[152:155], v11 offset:1216
    ds_read_b128 v[156:159], v11 offset:1728
    ds_read_b128 v[160:163], v11 offset:2240
    ds_read_b128 v[164:167], v11 offset:2752
    ds_read_b128 v[168:171], v11 offset:3264
    ds_read_b128 v[172:175], v11 offset:3776
    s_waitcnt lgkmcnt(7)
    v_mfma_f32_16x16x32_bf16 v[16:19], v[112:115], v[144:147], 0
    s_waitcnt lgkmcnt(6)
    v_mfma_f32_16x16x32_bf16 v[20:23], v[112:115], v[148:151], 0
    v_mfma_f32_16x16x32_bf16 v[20:23], v[116:119], v[144:147], v[20:23]
    s_waitcnt lgkmcnt(5)
    v_mfma_f32_16x16x32_bf16 v[24:27], v[112:115], v[152:155], 0
    v_mfma_f32_16x16x32_bf16 v[24:27], v[116:119], v[148:151], v[24:27]
    ds_read_b128 v[48:51], v8 offset:64
    v_mfma_f32_16x16x32_bf16 v[24:27], v[120:123], v[144:147], v[24:27]
    s_waitcnt lgkmcnt(5)
    v_mfma_f32_16x16x32_bf16 v[28:31], v[112:115], v[156:159], 0
    ds_read_b128 v[80:83], v11 offset:128
    v_mfma_f32_16x16x32_bf16 v[28:31], v[116:119], v[152:155], v[28:31]
    v_mfma_f32_16x16x32_bf16 v[28:31], v[120:123], v[148:151], v[28:31]
    ds_read_b128 v[52:55], v8 offset:576
    v_mfma_f32_16x16x32_bf16 v[28:31], v[124:127], v[144:147], v[28:31]
    s_waitcnt lgkmcnt(6)
    v_mfma_f32_16x16x32_bf16 v[32:35], v[112:115], v[160:163], 0
    ds_read_b128 v[84:87], v11 offset:640
    v_mfma_f32_16x16x32_bf16 v[32:35], v[116:119], v[156:159], v[32:35]
    v_mfma_f32_16x16x32_bf16 v[32:35], v[120:123], v[152:155], v[32:35]
    ds_read_b128 v[56:59], v8 offset:1088
    v_mfma_f32_16x16x32_bf16 v[32:35], v[124:127], v[148:151], v[32:35]
    v_mfma_f32_16x16x32_bf16 v[32:35], v[128:131], v[144:147], v[32:35]
    ds_read_b128 v[88:91], v11 offset:1152
    s_waitcnt lgkmcnt(8)
    v_mfma_f32_16x16x32_bf16 v[36:39], v[112:115], v[164:167], 0
    v_mfma_f32_16x16x32_bf16 v[36:39], v[116:119], v[160:163], v[36:39]
    ds_read_b128 v[60:63], v8 offset:1600
    v_mfma_f32_16x16x32_bf16 v[36:39], v[120:123], v[156:159], v[36:39]
    v_mfma_f32_16x16x32_bf16 v[36:39], v[124:127], v[152:155], v[36:39]
    ds_read_b128 v[92:95], v11 offset:1664
    v_mfma_f32_16x16x32_bf16 v[36:39], v[128:131], v[148:151], v[36:39]
    v_mfma_f32_16x16x32_bf16 v[36:39], v[132:135], v[144:147], v[36:39]
    ds_read_b128 v[64:67], v8 offset:2112
    s_waitcnt lgkmcnt(10)
    v_mfma_f32_16x16x32_bf16 v[40:43], v[112:115], v[168:171], 0
    v_mfma_f32_16x16x32_bf16 v[40:43], v[116:119], v[164:167], v[40:43]
    ds_read_b128 v[96:99], v11 offset:2176
    v_mfma_f32_16x16x32_bf16 v[40:43], v[120:123], v[160:163], v[40:43]
    v_mfma_f32_16x16x32_bf16 v[40:43], v[124:127], v[156:159], v[40:43]
    ds_read_b128 v[68:71], v8 offset:2624
    v_mfma_f32_16x16x32_bf16 v[40:43], v[128:131], v[152:155], v[40:43]
    v_mfma_f32_16x16x32_bf16 v[40:43], v[132:135], v[148:151], v[40:43]
    ds_read_b128 v[100:103], v11 offset:2688
    v_mfma_f32_16x16x32_bf16 v[40:43], v[136:139], v[144:147], v[40:43]
    s_waitcnt lgkmcnt(12)
    v_mfma_f32_16x16x32_bf16 v[44:47], v[112:115], v[172:175], 0
    ds_read_b128 v[72:75], v8 offset:3136
    v_mfma_f32_16x16x32_bf16 v[44:47], v[116:119], v[168:171], v[44:47]
    v_mfma_f32_16x16x32_bf16 v[44:47], v[120:123], v[164:167], v[44:47]
    ds_read_b128 v[104:107], v11 offset:3200
    v_mfma_f32_16x16x32_bf16 v[44:47], v[124:127], v[160:163], v[44:47]
    v_mfma_f32_16x16x32_bf16 v[44:47], v[128:131], v[156:159], v[44:47]
    ds_read_b128 v[76:79], v8 offset:3648
    v_mfma_f32_16x16x32_bf16 v[44:47], v[132:135], v[152:155], v[44:47]
    ds_read_b128 v[108:111], v11 offset:3712
    v_mfma_f32_16x16x32_bf16 v[44:47], v[136:139], v[148:151], v[44:47]
    v_mfma_f32_16x16x32_bf16 v[44:47], v[140:143], v[144:147], v[44:47]
    s_waitcnt lgkmcnt(14)
    v_mfma_f32_16x16x32_bf16 v[16:19], v[48:51], v[80:83], v[16:19]
    s_waitcnt lgkmcnt(12)
    v_mfma_f32_16x16x32_bf16 v[20:23], v[48:51], v[84:87], v[20:23]
    v_mfma_f32_16x16x32_bf16 v[20:23], v[52:55], v[80:83], v[20:23]
    s_waitcnt lgkmcnt(10)
    v_mfma_f32_16x16x32_bf16 v[24:27], v[48:51], v[88:91], v[24:27]
    v_mfma_f32_16x16x32_bf16 v[24:27], v[52:55], v[84:87], v[24:27]
    ds_read_b128 v[112:115], v8 offset:128
    v_mfma_f32_16x16x32_bf16 v[24:27], v[56:59], v[80:83], v[24:27]
    s_waitcnt lgkmcnt(9)
    v_mfma_f32_16x16x32_bf16 v[28:31], v[48:51], v[92:95], v[28:31]
    ds_read_b128 v[144:147], v11 offset:64
    v_mfma_f32_16x16x32_bf16 v[28:31], v[52:55], v[88:91], v[28:31]
    v_mfma_f32_16x16x32_bf16 v[28:31], v[56:59], v[84:87], v[28:31]
    ds_read_b128 v[116:119], v8 offset:640
    v_mfma_f32_16x16x32_bf16 v[28:31], v[60:63], v[80:83], v[28:31]
    s_waitcnt lgkmcnt(9)
    v_mfma_f32_16x16x32_bf16 v[32:35], v[48:51], v[96:99], v[32:35]
    ds_read_b128 v[148:151], v11 offset:576
    v_mfma_f32_16x16x32_bf16 v[32:35], v[52:55], v[92:95], v[32:35]
    v_mfma_f32_16x16x32_bf16 v[32:35], v[56:59], v[88:91], v[32:35]
    ds_read_b128 v[120:123], v8 offset:1152
    v_mfma_f32_16x16x32_bf16 v[32:35], v[60:63], v[84:87], v[32:35]
    v_mfma_f32_16x16x32_bf16 v[32:35], v[64:67], v[80:83], v[32:35]
    ds_read_b128 v[152:155], v11 offset:1088
    s_waitcnt lgkmcnt(10)
    v_mfma_f32_16x16x32_bf16 v[36:39], v[48:51], v[100:103], v[36:39]
    v_mfma_f32_16x16x32_bf16 v[36:39], v[52:55], v[96:99], v[36:39]
    ds_read_b128 v[124:127], v8 offset:1664
    v_mfma_f32_16x16x32_bf16 v[36:39], v[56:59], v[92:95], v[36:39]
    v_mfma_f32_16x16x32_bf16 v[36:39], v[60:63], v[88:91], v[36:39]
    ds_read_b128 v[156:159], v11 offset:1600
    v_mfma_f32_16x16x32_bf16 v[36:39], v[64:67], v[84:87], v[36:39]
    v_mfma_f32_16x16x32_bf16 v[36:39], v[68:71], v[80:83], v[36:39]
    ds_read_b128 v[128:131], v8 offset:2176
    s_waitcnt lgkmcnt(11)
    v_mfma_f32_16x16x32_bf16 v[40:43], v[48:51], v[104:107], v[40:43]
    v_mfma_f32_16x16x32_bf16 v[40:43], v[52:55], v[100:103], v[40:43]
    ds_read_b128 v[160:163], v11 offset:2112
    v_mfma_f32_16x16x32_bf16 v[40:43], v[56:59], v[96:99], v[40:43]
    v_mfma_f32_16x16x32_bf16 v[40:43], v[60:63], v[92:95], v[40:43]
    ds_read_b128 v[132:135], v8 offset:2688
    v_mfma_f32_16x16x32_bf16 v[40:43], v[64:67], v[88:91], v[40:43]
    v_mfma_f32_16x16x32_bf16 v[40:43], v[68:71], v[84:87], v[40:43]
    ds_read_b128 v[164:167], v11 offset:2624
    v_mfma_f32_16x16x32_bf16 v[40:43], v[72:75], v[80:83], v[40:43]
    s_waitcnt lgkmcnt(12)
    v_mfma_f32_16x16x32_bf16 v[44:47], v[48:51], v[108:111], v[44:47]
    ds_read_b128 v[136:139], v8 offset:3200
    v_mfma_f32_16x16x32_bf16 v[44:47], v[52:55], v[104:107], v[44:47]
    v_mfma_f32_16x16x32_bf16 v[44:47], v[56:59], v[100:103], v[44:47]
    ds_read_b128 v[168:171], v11 offset:3136
    v_mfma_f32_16x16x32_bf16 v[44:47], v[60:63], v[96:99], v[44:47]
    v_mfma_f32_16x16x32_bf16 v[44:47], v[64:67], v[92:95], v[44:47]
    ds_read_b128 v[140:143], v8 offset:3712
    v_mfma_f32_16x16x32_bf16 v[44:47], v[68:71], v[88:91], v[44:47]
    ds_read_b128 v[172:175], v11 offset:3648
    v_mfma_f32_16x16x32_bf16 v[44:47], v[72:75], v[84:87], v[44:47]
    v_mfma_f32_16x16x32_bf16 v[44:47], v[76:79], v[80:83], v[44:47]
    s_waitcnt lgkmcnt(14)
    v_mfma_f32_16x16x32_bf16 v[16:19], v[112:115], v[144:147], v[16:19]
    s_waitcnt lgkmcnt(12)
    v_mfma_f32_16x16x32_bf16 v[20:23], v[112:115], v[148:151], v[20:23]
    v_mfma_f32_16x16x32_bf16 v[20:23], v[116:119], v[144:147], v[20:23]
    s_waitcnt lgkmcnt(10)
    v_mfma_f32_16x16x32_bf16 v[24:27], v[112:115], v[152:155], v[24:27]
    v_mfma_f32_16x16x32_bf16 v[24:27], v[116:119], v[148:151], v[24:27]
    ds_read_b128 v[48:51], v8 offset:192
    v_mfma_f32_16x16x32_bf16 v[24:27], v[120:123], v[144:147], v[24:27]
    s_waitcnt lgkmcnt(9)
    v_mfma_f32_16x16x32_bf16 v[28:31], v[112:115], v[156:159], v[28:31]
    ds_read_b128 v[80:83], v11 offset:0
    v_mfma_f32_16x16x32_bf16 v[28:31], v[116:119], v[152:155], v[28:31]
    v_mfma_f32_16x16x32_bf16 v[28:31], v[120:123], v[148:151], v[28:31]
    ds_read_b128 v[52:55], v8 offset:704
    v_mfma_f32_16x16x32_bf16 v[28:31], v[124:127], v[144:147], v[28:31]
    s_waitcnt lgkmcnt(9)
    v_mfma_f32_16x16x32_bf16 v[32:35], v[112:115], v[160:163], v[32:35]
    ds_read_b128 v[84:87], v11 offset:512
    v_mfma_f32_16x16x32_bf16 v[32:35], v[116:119], v[156:159], v[32:35]
    v_mfma_f32_16x16x32_bf16 v[32:35], v[120:123], v[152:155], v[32:35]
    ds_read_b128 v[56:59], v8 offset:1216
    v_mfma_f32_16x16x32_bf16 v[32:35], v[124:127], v[148:151], v[32:35]
    v_mfma_f32_16x16x32_bf16 v[32:35], v[128:131], v[144:147], v[32:35]
    ds_read_b128 v[88:91], v11 offset:1024
    s_waitcnt lgkmcnt(10)
    v_mfma_f32_16x16x32_bf16 v[36:39], v[112:115], v[164:167], v[36:39]
    v_mfma_f32_16x16x32_bf16 v[36:39], v[116:119], v[160:163], v[36:39]
    ds_read_b128 v[60:63], v8 offset:1728
    v_mfma_f32_16x16x32_bf16 v[36:39], v[120:123], v[156:159], v[36:39]
    v_mfma_f32_16x16x32_bf16 v[36:39], v[124:127], v[152:155], v[36:39]
    ds_read_b128 v[92:95], v11 offset:1536
    v_mfma_f32_16x16x32_bf16 v[36:39], v[128:131], v[148:151], v[36:39]
    v_mfma_f32_16x16x32_bf16 v[36:39], v[132:135], v[144:147], v[36:39]
    ds_read_b128 v[64:67], v8 offset:2240
    s_waitcnt lgkmcnt(11)
    v_mfma_f32_16x16x32_bf16 v[40:43], v[112:115], v[168:171], v[40:43]
    v_mfma_f32_16x16x32_bf16 v[40:43], v[116:119], v[164:167], v[40:43]
    ds_read_b128 v[96:99], v11 offset:2048
    v_mfma_f32_16x16x32_bf16 v[40:43], v[120:123], v[160:163], v[40:43]
    v_mfma_f32_16x16x32_bf16 v[40:43], v[124:127], v[156:159], v[40:43]
    ds_read_b128 v[68:71], v8 offset:2752
    v_mfma_f32_16x16x32_bf16 v[40:43], v[128:131], v[152:155], v[40:43]
    v_mfma_f32_16x16x32_bf16 v[40:43], v[132:135], v[148:151], v[40:43]
    ds_read_b128 v[100:103], v11 offset:2560
    v_mfma_f32_16x16x32_bf16 v[40:43], v[136:139], v[144:147], v[40:43]
    s_waitcnt lgkmcnt(12)
    v_mfma_f32_16x16x32_bf16 v[44:47], v[112:115], v[172:175], v[44:47]
    ds_read_b128 v[72:75], v8 offset:3264
    v_mfma_f32_16x16x32_bf16 v[44:47], v[116:119], v[168:171], v[44:47]
    v_mfma_f32_16x16x32_bf16 v[44:47], v[120:123], v[164:167], v[44:47]
    ds_read_b128 v[104:107], v11 offset:3072
    v_mfma_f32_16x16x32_bf16 v[44:47], v[124:127], v[160:163], v[44:47]
    v_mfma_f32_16x16x32_bf16 v[44:47], v[128:131], v[156:159], v[44:47]
    ds_read_b128 v[76:79], v8 offset:3776
    v_mfma_f32_16x16x32_bf16 v[44:47], v[132:135], v[152:155], v[44:47]
    ds_read_b128 v[108:111], v11 offset:3584
    v_mfma_f32_16x16x32_bf16 v[44:47], v[136:139], v[148:151], v[44:47]
    v_mfma_f32_16x16x32_bf16 v[44:47], v[140:143], v[144:147], v[44:47]
    s_waitcnt lgkmcnt(14)
    v_mfma_f32_16x16x32_bf16 v[16:19], v[48:51], v[80:83], v[16:19]
    s_waitcnt lgkmcnt(12)
    v_mfma_f32_16x16x32_bf16 v[20:23], v[48:51], v[84:87], v[20:23]
    v_mfma_f32_16x16x32_bf16 v[20:23], v[52:55], v[80:83], v[20:23]
    s_waitcnt lgkmcnt(10)
    v_mfma_f32_16x16x32_bf16 v[24:27], v[48:51], v[88:91], v[24:27]
    v_mfma_f32_16x16x32_bf16 v[24:27], v[52:55], v[84:87], v[24:27]
    v_mfma_f32_16x16x32_bf16 v[24:27], v[56:59], v[80:83], v[24:27]
    s_waitcnt lgkmcnt(8)
    v_mfma_f32_16x16x32_bf16 v[28:31], v[48:51], v[92:95], v[28:31]
    v_mfma_f32_16x16x32_bf16 v[28:31], v[52:55], v[88:91], v[28:31]
    v_mfma_f32_16x16x32_bf16 v[28:31], v[56:59], v[84:87], v[28:31]
    v_mfma_f32_16x16x32_bf16 v[28:31], v[60:63], v[80:83], v[28:31]
    s_waitcnt lgkmcnt(6)
    v_mfma_f32_16x16x32_bf16 v[32:35], v[48:51], v[96:99], v[32:35]
    v_mfma_f32_16x16x32_bf16 v[32:35], v[52:55], v[92:95], v[32:35]
    v_mfma_f32_16x16x32_bf16 v[32:35], v[56:59], v[88:91], v[32:35]
    v_mfma_f32_16x16x32_bf16 v[32:35], v[60:63], v[84:87], v[32:35]
    v_mfma_f32_16x16x32_bf16 v[32:35], v[64:67], v[80:83], v[32:35]
    s_waitcnt lgkmcnt(4)
    v_mfma_f32_16x16x32_bf16 v[36:39], v[48:51], v[100:103], v[36:39]
    v_mfma_f32_16x16x32_bf16 v[36:39], v[52:55], v[96:99], v[36:39]
    v_mfma_f32_16x16x32_bf16 v[36:39], v[56:59], v[92:95], v[36:39]
    v_mfma_f32_16x16x32_bf16 v[36:39], v[60:63], v[88:91], v[36:39]
    v_mfma_f32_16x16x32_bf16 v[36:39], v[64:67], v[84:87], v[36:39]
    v_mfma_f32_16x16x32_bf16 v[36:39], v[68:71], v[80:83], v[36:39]
    s_waitcnt lgkmcnt(2)
    v_mfma_f32_16x16x32_bf16 v[40:43], v[48:51], v[104:107], v[40:43]
    v_mfma_f32_16x16x32_bf16 v[40:43], v[52:55], v[100:103], v[40:43]
    v_mfma_f32_16x16x32_bf16 v[40:43], v[56:59], v[96:99], v[40:43]
    v_mfma_f32_16x16x32_bf16 v[40:43], v[60:63], v[92:95], v[40:43]
    v_mfma_f32_16x16x32_bf16 v[40:43], v[64:67], v[88:91], v[40:43]
    v_mfma_f32_16x16x32_bf16 v[40:43], v[68:71], v[84:87], v[40:43]
    v_mfma_f32_16x16x32_bf16 v[40:43], v[72:75], v[80:83], v[40:43]
    s_waitcnt lgkmcnt(0)
    v_mfma_f32_16x16x32_bf16 v[44:47], v[48:51], v[108:111], v[44:47]
    v_mfma_f32_16x16x32_bf16 v[44:47], v[52:55], v[104:107], v[44:47]
    v_mfma_f32_16x16x32_bf16 v[44:47], v[56:59], v[100:103], v[44:47]
    v_mfma_f32_16x16x32_bf16 v[44:47], v[60:63], v[96:99], v[44:47]
    v_mfma_f32_16x16x32_bf16 v[44:47], v[64:67], v[92:95], v[44:47]
    v_mfma_f32_16x16x32_bf16 v[44:47], v[68:71], v[88:91], v[44:47]
    v_mfma_f32_16x16x32_bf16 v[44:47], v[72:75], v[84:87], v[44:47]
    v_mfma_f32_16x16x32_bf16 v[44:47], v[76:79], v[80:83], v[44:47]
    s_lshl_b32 s29, s3, 12
    s_add_u32 s29, s29, 142720
    v_add_u32 v4, s29, v7
    s_xor_b32 s29, s3, 1
    s_lshl_b32 s29, s29, 12
    s_add_u32 s29, s29, 142720
    v_add_u32 v5, s29, v7
    s_lshl_b32 s29, s3, 11
    s_lshl_b32 s57, s2, 13
    s_add_u32 s57, s57, s29
    s_add_u32 s57, s57, 5242880
    s_add_u32 s29, s29, 126336
    v_add_u32 v6, s29, v13
    v_add_u32 v9, s29, v7
    ds_read_b32 v112, v6 offset:0
    ds_read_b32 v113, v6 offset:16
    ds_read_b32 v114, v6 offset:8192
    ds_read_b32 v115, v6 offset:8208
    ds_read_b32 v116, v6 offset:512
    ds_read_b32 v117, v6 offset:528
    ds_read_b32 v118, v6 offset:8704
    ds_read_b32 v119, v6 offset:8720
    ds_read_b32 v120, v6 offset:1024
    ds_read_b32 v121, v6 offset:1040
    ds_read_b32 v122, v6 offset:9216
    ds_read_b32 v123, v6 offset:9232
    ds_read_b32 v124, v6 offset:1536
    ds_read_b32 v125, v6 offset:1552
    ds_read_b32 v126, v6 offset:9728
    ds_read_b32 v127, v6 offset:9744
    s_cmp_eq_u32 s69, 0
    s_cbranch_scc1 L2_r0
    ds_write_b128 v4, v[16:19] offset:0
    ds_write_b128 v4, v[20:23] offset:1024
    ds_write_b128 v4, v[24:27] offset:2048
    ds_write_b128 v4, v[28:31] offset:3072
    s_waitcnt lgkmcnt(0)
    v_mov_b32 v16, v32
    v_mov_b32 v17, v33
    v_mov_b32 v18, v34
    v_mov_b32 v19, v35
    v_mov_b32 v20, v36
    v_mov_b32 v21, v37
    v_mov_b32 v22, v38
    v_mov_b32 v23, v39
    v_mov_b32 v24, v40
    v_mov_b32 v25, v41
    v_mov_b32 v26, v42
    v_mov_b32 v27, v43
    v_mov_b32 v28, v44
    v_mov_b32 v29, v45
    v_mov_b32 v30, v46
    v_mov_b32 v31, v47
    s_branch L2_r1
L2_r0:
    ds_write_b128 v4, v[32:35] offset:0
    ds_write_b128 v4, v[36:39] offset:1024
    ds_write_b128 v4, v[40:43] offset:2048
    ds_write_b128 v4, v[44:47] offset:3072
L2_r1:
    s_lshl_b32 s29, s3, 2
    s_add_u32 s29, s29, 160768
    v_mov_b32 v8, s29
    v_xor_b32 v10, 4, v8
    ds_write_b32 v8, v8
    s_mov_b32 s31, 0
L_b5:
    ds_read_b32 v11, v10
    s_add_u32 s31, s31, 1
    s_waitcnt lgkmcnt(0)
    v_cmp_eq_u32 vcc, 0, v11
    s_cmp_gt_u32 s31, 100000
    s_cbranch_scc1 L_b5x
    s_cbranch_vccnz L_b5
L_b5x:
    ds_read_b128 v[48:51], v5 offset:0
    ds_read_b128 v[52:55], v5 offset:1024
    ds_read_b128 v[56:59], v5 offset:2048
    ds_read_b128 v[60:63], v5 offset:3072
    v_lshlrev_b32 v64, 16, v112
    v_and_b32 v65, 0xffff0000, v112
    v_lshlrev_b32 v80, 16, v114
    v_and_b32 v81, 0xffff0000, v114
    v_lshlrev_b32 v66, 16, v113
    v_and_b32 v67, 0xffff0000, v113
    v_lshlrev_b32 v82, 16, v115
    v_and_b32 v83, 0xffff0000, v115
    v_lshlrev_b32 v68, 16, v116
    v_and_b32 v69, 0xffff0000, v116
    v_lshlrev_b32 v84, 16, v118
    v_and_b32 v85, 0xffff0000, v118
    v_lshlrev_b32 v70, 16, v117
    v_and_b32 v71, 0xffff0000, v117
    v_lshlrev_b32 v86, 16, v119
    v_and_b32 v87, 0xffff0000, v119
    v_lshlrev_b32 v72, 16, v120
    v_and_b32 v73, 0xffff0000, v120
    v_lshlrev_b32 v88, 16, v122
    v_and_b32 v89, 0xffff0000, v122
    v_lshlrev_b32 v74, 16, v121
    v_and_b32 v75, 0xffff0000, v121
    v_lshlrev_b32 v90, 16, v123
    v_and_b32 v91, 0xffff0000, v123
    v_lshlrev_b32 v76, 16, v124
    v_and_b32 v77, 0xffff0000, v124
    v_lshlrev_b32 v92, 16, v126
    v_and_b32 v93, 0xffff0000, v126
    v_lshlrev_b32 v78, 16, v125
    v_and_b32 v79, 0xffff0000, v125
    v_lshlrev_b32 v94, 16, v127
    v_and_b32 v95, 0xffff0000, v127
    s_waitcnt lgkmcnt(3)
    v_add_f32 v16, v16, v48
    v_add_f32 v17, v17, v49
    v_add_f32 v18, v18, v50
    v_add_f32 v19, v19, v51
    v_cvt_pk_bf16_f32 v16, v16, v17
    v_cvt_pk_bf16_f32 v18, v18, v19
    v_and_b32 v17, 0xffff0000, v16
    v_and_b32 v19, 0xffff0000, v18
    v_lshlrev_b32 v16, 16, v16
    v_lshlrev_b32 v18, 16, v18
    v_add_f32 v16, v16, v80
    v_add_f32 v17, v17, v81
    v_add_f32 v18, v18, v82
    v_add_f32 v19, v19, v83
    v_cvt_pk_bf16_f32 v16, v16, v17
    v_cvt_pk_bf16_f32 v18, v18, v19
    v_and_b32 v17, 0xffff0000, v16
    v_and_b32 v19, 0xffff0000, v18
    v_lshlrev_b32 v16, 16, v16
    v_lshlrev_b32 v18, 16, v18
    v_add_f32 v16, v16, v64
    v_add_f32 v17, v17, v65
    v_add_f32 v18, v18, v66
    v_add_f32 v19, v19, v67
    v_cvt_pk_bf16_f32 v16, v16, v17
    v_cvt_pk_bf16_f32 v18, v18, v19
    ds_write_b32 v6, v16 offset:0
    ds_write_b32 v6, v18 offset:16
    s_waitcnt lgkmcnt(4)
    v_add_f32 v20, v20, v52
    v_add_f32 v21, v21, v53
    v_add_f32 v22, v22, v54
    v_add_f32 v23, v23, v55
    v_cvt_pk_bf16_f32 v20, v20, v21
    v_cvt_pk_bf16_f32 v22, v22, v23
    v_and_b32 v21, 0xffff0000, v20
    v_and_b32 v23, 0xffff0000, v22
    v_lshlrev_b32 v20, 16, v20
    v_lshlrev_b32 v22, 16, v22
    v_add_f32 v20, v20, v84
    v_add_f32 v21, v21, v85
    v_add_f32 v22, v22, v86
    v_add_f32 v23, v23, v87
    v_cvt_pk_bf16_f32 v20, v20, v21
    v_cvt_pk_bf16_f32 v22, v22, v23
    v_and_b32 v21, 0xffff0000, v20
    v_and_b32 v23, 0xffff0000, v22
    v_lshlrev_b32 v20, 16, v20
    v_lshlrev_b32 v22, 16, v22
    v_add_f32 v20, v20, v68
    v_add_f32 v21, v21, v69
    v_add_f32 v22, v22, v70
    v_add_f32 v23, v23, v71
    v_cvt_pk_bf16_f32 v20, v20, v21
    v_cvt_pk_bf16_f32 v22, v22, v23
    ds_write_b32 v6, v20 offset:512
    ds_write_b32 v6, v22 offset:528
    s_waitcnt lgkmcnt(5)
    v_add_f32 v24, v24, v56
    v_add_f32 v25, v25, v57
    v_add_f32 v26, v26, v58
    v_add_f32 v27, v27, v59
    v_cvt_pk_bf16_f32 v24, v24, v25
    v_cvt_pk_bf16_f32 v26, v26, v27
    v_and_b32 v25, 0xffff0000, v24
    v_and_b32 v27, 0xffff0000, v26
    v_lshlrev_b32 v24, 16, v24
    v_lshlrev_b32 v26, 16, v26
    v_add_f32 v24, v24, v88
    v_add_f32 v25, v25, v89
    v_add_f32 v26, v26, v90
    v_add_f32 v27, v27, v91
    v_cvt_pk_bf16_f32 v24, v24, v25
    v_cvt_pk_bf16_f32 v26, v26, v27
    v_and_b32 v25, 0xffff0000, v24
    v_and_b32 v27, 0xffff0000, v26
    v_lshlrev_b32 v24, 16, v24
    v_lshlrev_b32 v26, 16, v26
    v_add_f32 v24, v24, v72
    v_add_f32 v25, v25, v73
    v_add_f32 v26, v26, v74
    v_add_f32 v27, v27, v75
    v_cvt_pk_bf16_f32 v24, v24, v25
    v_cvt_pk_bf16_f32 v26, v26, v27
    ds_write_b32 v6, v24 offset:1024
    ds_write_b32 v6, v26 offset:1040
    s_waitcnt lgkmcnt(6)
    v_add_f32 v28, v28, v60
    v_add_f32 v29, v29, v61
    v_add_f32 v30, v30, v62
    v_add_f32 v31, v31, v63
    v_cvt_pk_bf16_f32 v28, v28, v29
    v_cvt_pk_bf16_f32 v30, v30, v31
    v_and_b32 v29, 0xffff0000, v28
    v_and_b32 v31, 0xffff0000, v30
    v_lshlrev_b32 v28, 16, v28
    v_lshlrev_b32 v30, 16, v30
    v_add_f32 v28, v28, v92
    v_add_f32 v29, v29, v93
    v_add_f32 v30, v30, v94
    v_add_f32 v31, v31, v95
    v_cvt_pk_bf16_f32 v28, v28, v29
    v_cvt_pk_bf16_f32 v30, v30, v31
    v_and_b32 v29, 0xffff0000, v28
    v_and_b32 v31, 0xffff0000, v30
    v_lshlrev_b32 v28, 16, v28
    v_lshlrev_b32 v30, 16, v30
    v_add_f32 v28, v28, v76
    v_add_f32 v29, v29, v77
    v_add_f32 v30, v30, v78
    v_add_f32 v31, v31, v79
    v_cvt_pk_bf16_f32 v28, v28, v29
    v_cvt_pk_bf16_f32 v30, v30, v31
    ds_write_b32 v6, v28 offset:1536
    ds_write_b32 v6, v30 offset:1552
    s_waitcnt lgkmcnt(0)
    ds_read_b128 v[48:51], v9
    ds_read_b128 v[52:55], v9 offset:1024
    s_waitcnt lgkmcnt(1)
    buffer_store_dwordx4 v[48:51], v7, s[4:7], s57 offen sc1
    s_waitcnt lgkmcnt(0)
    buffer_store_dwordx4 v[52:55], v7, s[4:7], s57 offen offset:1024 sc1
    v_lshrrev_b32 v3, 4, v2
    v_bfe_u32 v4, v2, 2, 2
    v_lshl_add_u32 v5, v3, 2, v4
    v_and_b32 v6, 3, v2
    v_mul_u32_u24 v8, 224, v5
    v_and_b32 v10, 1, v6
    v_lshl_add_u32 v10, v10, 3, v8
    v_lshrrev_b32 v11, 1, v6
    v_mul_u32_u24 v11, 7184, v11
    s_lshl_b32 s29, s66, 4
    s_add_u32 s29, s29, 96
    v_add3_u32 v10, v10, v11, s29
    v_add_u32 v11, 57856, v10
    v_lshl_add_u32 v8, v6, 3, v8
    s_lshl_b32 s29, s66, 7
    s_add_u32 s29, s29, 0
    v_add_u32 v8, s29, v8
    v_add_u32 v9, 57856, v8
    v_lshlrev_b32 v1, 8, v5
    v_lshl_add_u32 v1, v6, 3, v1
    v_add_u32 v1, 101248, v1
    v_and_b32 v5, 7, v5
    s_lshl_b32 s29, s69, 2
    v_xor_b32 v5, s29, v5
    v_xor_b32 v6, 0, v5
    v_lshl_add_u32 v12, v6, 5, v1
    v_xor_b32 v6, 1, v5
    v_lshl_add_u32 v13, v6, 5, v1
    v_xor_b32 v6, 2, v5
    v_lshl_add_u32 v14, v6, 5, v1
    v_xor_b32 v6, 3, v5
    v_lshl_add_u32 v15, v6, 5, v1
    v_and_b32 v1, 15, v2
    v_lshlrev_b32 v6, 4, v1
    s_lshl_b32 s29, s66, 11
    s_add_u32 s29, s29, 156544
    v_add_u32 v4, s29, v6
    v_lshrrev_b32 v5, 3, v1
    v_lshl_add_u32 v5, v5, 7, v6
    s_lshl_b32 s29, s66, 7
    s_add_u32 s29, s29, 158080
    v_add_u32 v5, s29, v5
    s_lshl_b32 s29, s69, 10
    s_add_u32 s29, s29, 154496
    v_add_u32 v6, s29, v6
    v_add_u32 v1, s29, v7
    v_cmp_eq_u32 s[56:57], 0, v3
    s_lshl_b32 s70, s61, 1
    s_add_u32 s70, s70, s69
    s_mul_i32 s70, s70, 224
    s_mul_i32 s29, s62, 7
    s_add_u32 s70, s70, s29
    s_add_u32 s71, s70, 3
    s_lshl_b32 s29, s66, 2
    s_add_u32 s70, s70, s29
    s_lshl_b32 s70, s70, 10
    s_add_u32 s70, s70, 8388608
    s_lshl_b32 s71, s71, 10
    s_lshl_b32 s29, s66, 9
    s_add_u32 s71, s71, s29
    s_add_u32 s71, s71, 8388608
    v_lshlrev_b32 v3, 6, v2
    s_lshl_b32 s29, s2, 6
    s_add_u32 s29, s29, 21037056
    s_waitcnt vmcnt(0)
    s_barrier
    s_cmp_lg_u32 s3, 0
    s_cbranch_scc1 L_f2x
    v_mov_b32 v48, s60
    v_mov_b32 v49, 0
    s_mov_b64 exec, 1
    buffer_store_dword v48, v49, s[4:7], s29 offen sc1
    s_mov_b64 exec, -1
L_f2x:
    buffer_load_dwordx4 v[176:179], v7, s[4:7], s67 offen offset:0 sc1
    buffer_load_dwordx4 v[180:183], v7, s[4:7], s67 offen offset:1024 sc1
    buffer_load_dwordx4 v[184:187], v7, s[4:7], s67 offen offset:2048 sc1
    buffer_load_dwordx4 v[188:191], v7, s[4:7], s67 offen offset:3072 sc1
    s_add_u32 s67, s67, 4096
    buffer_load_dwordx4 v[192:195], v7, s[4:7], s67 offen offset:0 sc1
    buffer_load_dwordx4 v[196:199], v7, s[4:7], s67 offen offset:1024 sc1
    buffer_load_dwordx4 v[200:203], v7, s[4:7], s67 offen offset:2048 sc1
    buffer_load_dwordx4 v[204:207], v7, s[4:7], s67 offen offset:3072 sc1
    s_add_u32 s67, s67, 4096
    buffer_load_dwordx4 v[208:211], v7, s[4:7], s67 offen offset:0 sc1
    buffer_load_dwordx4 v[212:215], v7, s[4:7], s67 offen offset:1024 sc1
    s_cmp_lg_u32 s3, 1
    s_cbranch_scc1 L_p2x
    s_mov_b32 s29, 0x1410000
    s_sleep 32
    s_mov_b32 s31, 0
L_p2:
    buffer_load_dword v48, v3, s[4:7], s29 offen sc1
    s_add_u32 s30, s29, 4096
    buffer_load_dword v49, v3, s[4:7], s30 offen sc1
    s_add_u32 s30, s29, 8192
    buffer_load_dword v50, v3, s[4:7], s30 offen sc1
    s_add_u32 s30, s29, 12288
    buffer_load_dword v51, v3, s[4:7], s30 offen sc1
    s_add_u32 s31, s31, 1
    s_waitcnt vmcnt(0)
    v_xor_b32 v48, s60, v48
    v_xor_b32 v49, s60, v49
    v_xor_b32 v50, s60, v50
    v_xor_b32 v51, s60, v51
    v_or_b32 v48, v48, v49
    v_or_b32 v48, v48, v50
    v_or_b32 v48, v48, v51
    v_cmp_ne_u32 vcc, 0, v48
    s_cmp_gt_u32 s31, 4000
    s_cbranch_scc1 L_p2x
    s_cbranch_vccz L_p2x
    s_sleep 2
    s_branch L_p2
L_p2x:
    s_barrier
    s_barrier
    ds_read_b64_tr_b16 v[16:17], v12 offset:0
    ds_read_b64_tr_b16 v[18:19], v12 offset:4096
    ds_read_b64_tr_b16 v[48:49], v8 offset:0
    ds_read_b64_tr_b16 v[50:51], v8 offset:3584
    ds_read_b64_tr_b16 v[20:21], v13 offset:0
    ds_read_b64_tr_b16 v[22:23], v13 offset:4096
    ds_read_b64_tr_b16 v[24:25], v14 offset:0
    ds_read_b64_tr_b16 v[26:27], v14 offset:4096
    ds_read_b64_tr_b16 v[28:29], v15 offset:0
    ds_read_b64_tr_b16 v[30:31], v15 offset:4096
    ds_read_b64_tr_b16 v[52:53], v8 offset:7184
    ds_read_b64_tr_b16 v[54:55], v8 offset:10768
    ds_read_b64_tr_b16 v[56:57], v8 offset:32
    ds_read_b64_tr_b16 v[58:59], v8 offset:3616
    ds_read_b64_tr_b16 v[60:61], v8 offset:7216
    ds_read_b64_tr_b16 v[62:63], v8 offset:10800
    s_waitcnt lgkmcnt(12)
    v_mfma_f32_16x16x32_bf16 v[64:67], v[48:51], v[16:19], 0
    s_waitcnt lgkmcnt(10)
    v_mfma_f32_16x16x32_bf16 v[68:71], v[48:51], v[20:23], 0
    s_waitcnt lgkmcnt(8)
    v_mfma_f32_16x16x32_bf16 v[72:75], v[48:51], v[24:27], 0
    s_waitcnt lgkmcnt(6)
    v_mfma_f32_16x16x32_bf16 v[76:79], v[48:51], v[28:31], 0
    ds_read_b64_tr_b16 v[48:49], v8 offset:64
    s_waitcnt lgkmcnt(5)
    v_mfma_f32_16x16x32_bf16 v[80:83], v[52:55], v[16:19], 0
    ds_read_b64_tr_b16 v[50:51], v8 offset:3648
    v_mfma_f32_16x16x32_bf16 v[84:87], v[52:55], v[20:23], 0
    v_mfma_f32_16x16x32_bf16 v[88:91], v[52:55], v[24:27], 0
    v_mfma_f32_16x16x32_bf16 v[92:95], v[52:55], v[28:31], 0
    ds_read_b64_tr_b16 v[52:53], v8 offset:7248
    s_waitcnt lgkmcnt(5)
    v_mfma_f32_16x16x32_bf16 v[96:99], v[56:59], v[16:19], 0
    ds_read_b64_tr_b16 v[54:55], v8 offset:10832
    v_mfma_f32_16x16x32_bf16 v[100:103], v[56:59], v[20:23], 0
    s_barrier
    ds_read_b64_tr_b16 v[32:33], v12 offset:8192
    v_mfma_f32_16x16x32_bf16 v[104:107], v[56:59], v[24:27], 0
    ds_read_b64_tr_b16 v[34:35], v12 offset:12288
    v_mfma_f32_16x16x32_bf16 v[108:111], v[56:59], v[28:31], 0
    ds_read_b64_tr_b16 v[56:57], v10 offset:0
    s_waitcnt lgkmcnt(7)
    v_mfma_f32_16x16x32_bf16 v[112:115], v[60:63], v[16:19], 0
    ds_read_b64_tr_b16 v[58:59], v10 offset:3584
    v_mfma_f32_16x16x32_bf16 v[116:119], v[60:63], v[20:23], 0
    ds_read_b64_tr_b16 v[36:37], v13 offset:8192
    v_mfma_f32_16x16x32_bf16 v[120:123], v[60:63], v[24:27], 0
    ds_read_b64_tr_b16 v[38:39], v13 offset:12288
    v_mfma_f32_16x16x32_bf16 v[124:127], v[60:63], v[28:31], 0
    ds_read_b64_tr_b16 v[60:61], v8 offset:14464
    s_waitcnt lgkmcnt(9)
    v_mfma_f32_16x16x32_bf16 v[128:131], v[48:51], v[16:19], 0
    ds_read_b64_tr_b16 v[62:63], v8 offset:18048
    v_mfma_f32_16x16x32_bf16 v[132:135], v[48:51], v[20:23], 0
    ds_read_b64_tr_b16 v[40:41], v14 offset:8192
    v_mfma_f32_16x16x32_bf16 v[136:139], v[48:51], v[24:27], 0
    ds_read_b64_tr_b16 v[42:43], v14 offset:12288
    v_mfma_f32_16x16x32_bf16 v[140:143], v[48:51], v[28:31], 0
    ds_read_b64_tr_b16 v[48:49], v8 offset:21648
    s_waitcnt lgkmcnt(11)
    v_mfma_f32_16x16x32_bf16 v[144:147], v[52:55], v[16:19], 0
    ds_read_b64_tr_b16 v[50:51], v8 offset:25232
    v_mfma_f32_16x16x32_bf16 v[148:151], v[52:55], v[20:23], 0
    ds_read_b64_tr_b16 v[44:45], v15 offset:8192
    v_mfma_f32_16x16x32_bf16 v[152:155], v[52:55], v[24:27], 0
    ds_read_b64_tr_b16 v[46:47], v15 offset:12288
    v_mfma_f32_16x16x32_bf16 v[156:159], v[52:55], v[28:31], 0
    ds_read_b64_tr_b16 v[52:53], v8 offset:14496
    s_waitcnt lgkmcnt(11)
    v_mfma_f32_16x16x32_bf16 v[160:163], v[56:59], v[16:19], 0
    ds_read_b64_tr_b16 v[54:55], v8 offset:18080
    v_mfma_f32_16x16x32_bf16 v[164:167], v[56:59], v[20:23], 0
    v_mfma_f32_16x16x32_bf16 v[168:171], v[56:59], v[24:27], 0
    v_mfma_f32_16x16x32_bf16 v[172:175], v[56:59], v[28:31], 0
    ds_read_b64_tr_b16 v[56:57], v8 offset:21680
    s_waitcnt lgkmcnt(9)
    v_mfma_f32_16x16x32_bf16 v[64:67], v[60:63], v[32:35], v[64:67]
    ds_read_b64_tr_b16 v[58:59], v8 offset:25264
    v_mfma_f32_16x16x32_bf16 v[68:71], v[60:63], v[36:39], v[68:71]
    s_waitcnt lgkmcnt(8)
    v_mfma_f32_16x16x32_bf16 v[72:75], v[60:63], v[40:43], v[72:75]
    s_waitcnt lgkmcnt(4)
    v_mfma_f32_16x16x32_bf16 v[76:79], v[60:63], v[44:47], v[76:79]
    ds_read_b64_tr_b16 v[60:61], v8 offset:14528
    v_mfma_f32_16x16x32_bf16 v[80:83], v[48:51], v[32:35], v[80:83]
    ds_read_b64_tr_b16 v[62:63], v8 offset:18112
    v_mfma_f32_16x16x32_bf16 v[84:87], v[48:51], v[36:39], v[84:87]
    v_mfma_f32_16x16x32_bf16 v[88:91], v[48:51], v[40:43], v[88:91]
    v_mfma_f32_16x16x32_bf16 v[92:95], v[48:51], v[44:47], v[92:95]
    ds_read_b64_tr_b16 v[48:49], v8 offset:21712
    s_waitcnt lgkmcnt(5)
    v_mfma_f32_16x16x32_bf16 v[96:99], v[52:55], v[32:35], v[96:99]
    ds_read_b64_tr_b16 v[50:51], v8 offset:25296
    v_mfma_f32_16x16x32_bf16 v[100:103], v[52:55], v[36:39], v[100:103]
    s_barrier
    ds_read_b64_tr_b16 v[16:17], v12 offset:16384
    v_mfma_f32_16x16x32_bf16 v[104:107], v[52:55], v[40:43], v[104:107]
    ds_read_b64_tr_b16 v[18:19], v12 offset:20480
    v_mfma_f32_16x16x32_bf16 v[108:111], v[52:55], v[44:47], v[108:111]
    ds_read_b64_tr_b16 v[52:53], v10 offset:14464
    s_waitcnt lgkmcnt(7)
    v_mfma_f32_16x16x32_bf16 v[112:115], v[56:59], v[32:35], v[112:115]
    ds_read_b64_tr_b16 v[54:55], v10 offset:18048
    v_mfma_f32_16x16x32_bf16 v[116:119], v[56:59], v[36:39], v[116:119]
    ds_read_b64_tr_b16 v[20:21], v13 offset:16384
    v_mfma_f32_16x16x32_bf16 v[120:123], v[56:59], v[40:43], v[120:123]
    ds_read_b64_tr_b16 v[22:23], v13 offset:20480
    v_mfma_f32_16x16x32_bf16 v[124:127], v[56:59], v[44:47], v[124:127]
    ds_read_b64_tr_b16 v[56:57], v8 offset:28928
    s_waitcnt lgkmcnt(9)
    v_mfma_f32_16x16x32_bf16 v[128:131], v[60:63], v[32:35], v[128:131]
    ds_read_b64_tr_b16 v[58:59], v8 offset:32512
    v_mfma_f32_16x16x32_bf16 v[132:135], v[60:63], v[36:39], v[132:135]
    ds_read_b64_tr_b16 v[24:25], v14 offset:16384
    v_mfma_f32_16x16x32_bf16 v[136:139], v[60:63], v[40:43], v[136:139]
    ds_read_b64_tr_b16 v[26:27], v14 offset:20480
    v_mfma_f32_16x16x32_bf16 v[140:143], v[60:63], v[44:47], v[140:143]
    ds_read_b64_tr_b16 v[60:61], v8 offset:36112
    s_waitcnt lgkmcnt(11)
    v_mfma_f32_16x16x32_bf16 v[144:147], v[48:51], v[32:35], v[144:147]
    ds_read_b64_tr_b16 v[62:63], v8 offset:39696
    v_mfma_f32_16x16x32_bf16 v[148:151], v[48:51], v[36:39], v[148:151]
    ds_read_b64_tr_b16 v[28:29], v15 offset:16384
    v_mfma_f32_16x16x32_bf16 v[152:155], v[48:51], v[40:43], v[152:155]
    ds_read_b64_tr_b16 v[30:31], v15 offset:20480
    v_mfma_f32_16x16x32_bf16 v[156:159], v[48:51], v[44:47], v[156:159]
    ds_read_b64_tr_b16 v[48:49], v8 offset:28960
    s_waitcnt lgkmcnt(11)
    v_mfma_f32_16x16x32_bf16 v[160:163], v[52:55], v[32:35], v[160:163]
    ds_read_b64_tr_b16 v[50:51], v8 offset:32544
    v_mfma_f32_16x16x32_bf16 v[164:167], v[52:55], v[36:39], v[164:167]
    v_mfma_f32_16x16x32_bf16 v[168:171], v[52:55], v[40:43], v[168:171]
    v_mfma_f32_16x16x32_bf16 v[172:175], v[52:55], v[44:47], v[172:175]
    ds_read_b64_tr_b16 v[52:53], v8 offset:36144
    s_waitcnt lgkmcnt(9)
    v_mfma_f32_16x16x32_bf16 v[64:67], v[56:59], v[16:19], v[64:67]
    ds_read_b64_tr_b16 v[54:55], v8 offset:39728
    v_mfma_f32_16x16x32_bf16 v[68:71], v[56:59], v[20:23], v[68:71]
    s_waitcnt lgkmcnt(8)
    v_mfma_f32_16x16x32_bf16 v[72:75], v[56:59], v[24:27], v[72:75]
    s_waitcnt lgkmcnt(4)
    v_mfma_f32_16x16x32_bf16 v[76:79], v[56:59], v[28:31], v[76:79]
    ds_read_b64_tr_b16 v[56:57], v8 offset:28992
    v_mfma_f32_16x16x32_bf16 v[80:83], v[60:63], v[16:19], v[80:83]
    ds_read_b64_tr_b16 v[58:59], v8 offset:32576
    v_mfma_f32_16x16x32_bf16 v[84:87], v[60:63], v[20:23], v[84:87]
    v_mfma_f32_16x16x32_bf16 v[88:91], v[60:63], v[24:27], v[88:91]
    v_mfma_f32_16x16x32_bf16 v[92:95], v[60:63], v[28:31], v[92:95]
    ds_read_b64_tr_b16 v[60:61], v8 offset:36176
    s_waitcnt lgkmcnt(5)
    v_mfma_f32_16x16x32_bf16 v[96:99], v[48:51], v[16:19], v[96:99]
    ds_read_b64_tr_b16 v[62:63], v8 offset:39760
    v_mfma_f32_16x16x32_bf16 v[100:103], v[48:51], v[20:23], v[100:103]
    s_barrier
    ds_read_b64_tr_b16 v[32:33], v12 offset:24576
    v_mfma_f32_16x16x32_bf16 v[104:107], v[48:51], v[24:27], v[104:107]
    ds_read_b64_tr_b16 v[34:35], v12 offset:28672
    v_mfma_f32_16x16x32_bf16 v[108:111], v[48:51], v[28:31], v[108:111]
    ds_read_b64_tr_b16 v[48:49], v10 offset:28928
    s_waitcnt lgkmcnt(7)
    v_mfma_f32_16x16x32_bf16 v[112:115], v[52:55], v[16:19], v[112:115]
    ds_read_b64_tr_b16 v[50:51], v10 offset:32512
    v_mfma_f32_16x16x32_bf16 v[116:119], v[52:55], v[20:23], v[116:119]
    ds_read_b64_tr_b16 v[36:37], v13 offset:24576
    v_mfma_f32_16x16x32_bf16 v[120:123], v[52:55], v[24:27], v[120:123]
    ds_read_b64_tr_b16 v[38:39], v13 offset:28672
    v_mfma_f32_16x16x32_bf16 v[124:127], v[52:55], v[28:31], v[124:127]
    ds_read_b64_tr_b16 v[52:53], v8 offset:43392
    s_waitcnt lgkmcnt(9)
    v_mfma_f32_16x16x32_bf16 v[128:131], v[56:59], v[16:19], v[128:131]
    ds_read_b64_tr_b16 v[54:55], v8 offset:46976
    v_mfma_f32_16x16x32_bf16 v[132:135], v[56:59], v[20:23], v[132:135]
    ds_read_b64_tr_b16 v[40:41], v14 offset:24576
    v_mfma_f32_16x16x32_bf16 v[136:139], v[56:59], v[24:27], v[136:139]
    ds_read_b64_tr_b16 v[42:43], v14 offset:28672
    v_mfma_f32_16x16x32_bf16 v[140:143], v[56:59], v[28:31], v[140:143]
    ds_read_b64_tr_b16 v[56:57], v8 offset:50576
    s_waitcnt lgkmcnt(11)
    v_mfma_f32_16x16x32_bf16 v[144:147], v[60:63], v[16:19], v[144:147]
    ds_read_b64_tr_b16 v[58:59], v8 offset:54160
    v_mfma_f32_16x16x32_bf16 v[148:151], v[60:63], v[20:23], v[148:151]
    ds_read_b64_tr_b16 v[44:45], v15 offset:24576
    v_mfma_f32_16x16x32_bf16 v[152:155], v[60:63], v[24:27], v[152:155]
    ds_read_b64_tr_b16 v[46:47], v15 offset:28672
    v_mfma_f32_16x16x32_bf16 v[156:159], v[60:63], v[28:31], v[156:159]
    ds_read_b64_tr_b16 v[60:61], v8 offset:43424
    s_waitcnt lgkmcnt(11)
    v_mfma_f32_16x16x32_bf16 v[160:163], v[48:51], v[16:19], v[160:163]
    ds_read_b64_tr_b16 v[62:63], v8 offset:47008
    v_mfma_f32_16x16x32_bf16 v[164:167], v[48:51], v[20:23], v[164:167]
    v_mfma_f32_16x16x32_bf16 v[168:171], v[48:51], v[24:27], v[168:171]
    v_mfma_f32_16x16x32_bf16 v[172:175], v[48:51], v[28:31], v[172:175]
    ds_read_b64_tr_b16 v[48:49], v8 offset:50608
    s_waitcnt lgkmcnt(9)
    v_mfma_f32_16x16x32_bf16 v[64:67], v[52:55], v[32:35], v[64:67]
    ds_read_b64_tr_b16 v[50:51], v8 offset:54192
    v_mfma_f32_16x16x32_bf16 v[68:71], v[52:55], v[36:39], v[68:71]
    s_waitcnt lgkmcnt(8)
    v_mfma_f32_16x16x32_bf16 v[72:75], v[52:55], v[40:43], v[72:75]
    s_waitcnt lgkmcnt(4)
    v_mfma_f32_16x16x32_bf16 v[76:79], v[52:55], v[44:47], v[76:79]
    ds_read_b64_tr_b16 v[52:53], v8 offset:43456
    v_mfma_f32_16x16x32_bf16 v[80:83], v[56:59], v[32:35], v[80:83]
    ds_read_b64_tr_b16 v[54:55], v8 offset:47040
    v_mfma_f32_16x16x32_bf16 v[84:87], v[56:59], v[36:39], v[84:87]
    v_mfma_f32_16x16x32_bf16 v[88:91], v[56:59], v[40:43], v[88:91]
    v_mfma_f32_16x16x32_bf16 v[92:95], v[56:59], v[44:47], v[92:95]
    ds_read_b64_tr_b16 v[56:57], v8 offset:50640
    s_waitcnt lgkmcnt(5)
    v_mfma_f32_16x16x32_bf16 v[96:99], v[60:63], v[32:35], v[96:99]
    ds_read_b64_tr_b16 v[58:59], v8 offset:54224
    v_mfma_f32_16x16x32_bf16 v[100:103], v[60:63], v[36:39], v[100:103]
    s_barrier
    ds_read_b64_tr_b16 v[16:17], v12 offset:32768
    v_mfma_f32_16x16x32_bf16 v[104:107], v[60:63], v[40:43], v[104:107]
    ds_read_b64_tr_b16 v[18:19], v12 offset:36864
    v_mfma_f32_16x16x32_bf16 v[108:111], v[60:63], v[44:47], v[108:111]
    ds_read_b64_tr_b16 v[60:61], v10 offset:43392
    s_waitcnt lgkmcnt(7)
    v_mfma_f32_16x16x32_bf16 v[112:115], v[48:51], v[32:35], v[112:115]
    ds_read_b64_tr_b16 v[62:63], v10 offset:46976
    v_mfma_f32_16x16x32_bf16 v[116:119], v[48:51], v[36:39], v[116:119]
    ds_read_b64_tr_b16 v[20:21], v13 offset:32768
    v_mfma_f32_16x16x32_bf16 v[120:123], v[48:51], v[40:43], v[120:123]
    ds_read_b64_tr_b16 v[22:23], v13 offset:36864
    v_mfma_f32_16x16x32_bf16 v[124:127], v[48:51], v[44:47], v[124:127]
    ds_read_b64_tr_b16 v[48:49], v9 offset:0
    s_waitcnt lgkmcnt(9)
    v_mfma_f32_16x16x32_bf16 v[128:131], v[52:55], v[32:35], v[128:131]
    ds_read_b64_tr_b16 v[50:51], v9 offset:3584
    v_mfma_f32_16x16x32_bf16 v[132:135], v[52:55], v[36:39], v[132:135]
    ds_read_b64_tr_b16 v[24:25], v14 offset:32768
    v_mfma_f32_16x16x32_bf16 v[136:139], v[52:55], v[40:43], v[136:139]
    ds_read_b64_tr_b16 v[26:27], v14 offset:36864
    v_mfma_f32_16x16x32_bf16 v[140:143], v[52:55], v[44:47], v[140:143]
    ds_read_b64_tr_b16 v[52:53], v9 offset:7184
    s_waitcnt lgkmcnt(11)
    v_mfma_f32_16x16x32_bf16 v[144:147], v[56:59], v[32:35], v[144:147]
    ds_read_b64_tr_b16 v[54:55], v9 offset:10768
    v_mfma_f32_16x16x32_bf16 v[148:151], v[56:59], v[36:39], v[148:151]
    ds_read_b64_tr_b16 v[28:29], v15 offset:32768
    v_mfma_f32_16x16x32_bf16 v[152:155], v[56:59], v[40:43], v[152:155]
    ds_read_b64_tr_b16 v[30:31], v15 offset:36864
    v_mfma_f32_16x16x32_bf16 v[156:159], v[56:59], v[44:47], v[156:159]
    ds_read_b64_tr_b16 v[56:57], v9 offset:32
    s_waitcnt lgkmcnt(11)
    v_mfma_f32_16x16x32_bf16 v[160:163], v[60:63], v[32:35], v[160:163]
    ds_read_b64_tr_b16 v[58:59], v9 offset:3616
    v_mfma_f32_16x16x32_bf16 v[164:167], v[60:63], v[36:39], v[164:167]
    v_mfma_f32_16x16x32_bf16 v[168:171], v[60:63], v[40:43], v[168:171]
    v_mfma_f32_16x16x32_bf16 v[172:175], v[60:63], v[44:47], v[172:175]
    ds_read_b64_tr_b16 v[60:61], v9 offset:7216
    s_waitcnt lgkmcnt(9)
    v_mfma_f32_16x16x32_bf16 v[64:67], v[48:51], v[16:19], v[64:67]
    ds_read_b64_tr_b16 v[62:63], v9 offset:10800
    v_mfma_f32_16x16x32_bf16 v[68:71], v[48:51], v[20:23], v[68:71]
    s_waitcnt lgkmcnt(8)
    v_mfma_f32_16x16x32_bf16 v[72:75], v[48:51], v[24:27], v[72:75]
    s_waitcnt lgkmcnt(4)
    v_mfma_f32_16x16x32_bf16 v[76:79], v[48:51], v[28:31], v[76:79]
    ds_read_b64_tr_b16 v[48:49], v9 offset:64
    v_mfma_f32_16x16x32_bf16 v[80:83], v[52:55], v[16:19], v[80:83]
    ds_read_b64_tr_b16 v[50:51], v9 offset:3648
    v_mfma_f32_16x16x32_bf16 v[84:87], v[52:55], v[20:23], v[84:87]
    v_mfma_f32_16x16x32_bf16 v[88:91], v[52:55], v[24:27], v[88:91]
    v_mfma_f32_16x16x32_bf16 v[92:95], v[52:55], v[28:31], v[92:95]
    ds_read_b64_tr_b16 v[52:53], v9 offset:7248
    s_waitcnt lgkmcnt(5)
    v_mfma_f32_16x16x32_bf16 v[96:99], v[56:59], v[16:19], v[96:99]
    ds_read_b64_tr_b16 v[54:55], v9 offset:10832
    v_mfma_f32_16x16x32_bf16 v[100:103], v[56:59], v[20:23], v[100:103]
    s_barrier
    ds_read_b64_tr_b16 v[32:33], v12 offset:40960
    v_mfma_f32_16x16x32_bf16 v[104:107], v[56:59], v[24:27], v[104:107]
    ds_read_b64_tr_b16 v[34:35], v12 offset:45056
    v_mfma_f32_16x16x32_bf16 v[108:111], v[56:59], v[28:31], v[108:111]
    ds_read_b64_tr_b16 v[56:57], v11 offset:0
    s_waitcnt lgkmcnt(7)
    v_mfma_f32_16x16x32_bf16 v[112:115], v[60:63], v[16:19], v[112:115]
    ds_read_b64_tr_b16 v[58:59], v11 offset:3584
    v_mfma_f32_16x16x32_bf16 v[116:119], v[60:63], v[20:23], v[116:119]
    ds_read_b64_tr_b16 v[36:37], v13 offset:40960
    v_mfma_f32_16x16x32_bf16 v[120:123], v[60:63], v[24:27], v[120:123]
    ds_read_b64_tr_b16 v[38:39], v13 offset:45056
    v_mfma_f32_16x16x32_bf16 v[124:127], v[60:63], v[28:31], v[124:127]
    ds_read_b64_tr_b16 v[60:61], v9 offset:14464
    s_waitcnt lgkmcnt(9)
    v_mfma_f32_16x16x32_bf16 v[128:131], v[48:51], v[16:19], v[128:131]
    ds_read_b64_tr_b16 v[62:63], v9 offset:18048
    v_mfma_f32_16x16x32_bf16 v[132:135], v[48:51], v[20:23], v[132:135]
    ds_read_b64_tr_b16 v[40:41], v14 offset:40960
    v_mfma_f32_16x16x32_bf16 v[136:139], v[48:51], v[24:27], v[136:139]
    ds_read_b64_tr_b16 v[42:43], v14 offset:45056
    v_mfma_f32_16x16x32_bf16 v[140:143], v[48:51], v[28:31], v[140:143]
    ds_read_b64_tr_b16 v[48:49], v9 offset:21648
    s_waitcnt lgkmcnt(11)
    v_mfma_f32_16x16x32_bf16 v[144:147], v[52:55], v[16:19], v[144:147]
    ds_read_b64_tr_b16 v[50:51], v9 offset:25232
    v_mfma_f32_16x16x32_bf16 v[148:151], v[52:55], v[20:23], v[148:151]
    ds_read_b64_tr_b16 v[44:45], v15 offset:40960
    v_mfma_f32_16x16x32_bf16 v[152:155], v[52:55], v[24:27], v[152:155]
    ds_read_b64_tr_b16 v[46:47], v15 offset:45056
    v_mfma_f32_16x16x32_bf16 v[156:159], v[52:55], v[28:31], v[156:159]
    ds_read_b64_tr_b16 v[52:53], v9 offset:14496
    s_waitcnt lgkmcnt(11)
    v_mfma_f32_16x16x32_bf16 v[160:163], v[56:59], v[16:19], v[160:163]
    ds_read_b64_tr_b16 v[54:55], v9 offset:18080
    v_mfma_f32_16x16x32_bf16 v[164:167], v[56:59], v[20:23], v[164:167]
    v_mfma_f32_16x16x32_bf16 v[168:171], v[56:59], v[24:27], v[168:171]
    v_mfma_f32_16x16x32_bf16 v[172:175], v[56:59], v[28:31], v[172:175]
    ds_read_b64_tr_b16 v[56:57], v9 offset:21680
    s_waitcnt lgkmcnt(9)
    v_mfma_f32_16x16x32_bf16 v[64:67], v[60:63], v[32:35], v[64:67]
    ds_read_b64_tr_b16 v[58:59], v9 offset:25264
    v_mfma_f32_16x16x32_bf16 v[68:71], v[60:63], v[36:39], v[68:71]
    s_waitcnt lgkmcnt(8)
    v_mfma_f32_16x16x32_bf16 v[72:75], v[60:63], v[40:43], v[72:75]
    s_waitcnt lgkmcnt(4)
    v_mfma_f32_16x16x32_bf16 v[76:79], v[60:63], v[44:47], v[76:79]
    ds_read_b64_tr_b16 v[60:61], v9 offset:14528
    v_mfma_f32_16x16x32_bf16 v[80:83], v[48:51], v[32:35], v[80:83]
    ds_read_b64_tr_b16 v[62:63], v9 offset:18112
    v_mfma_f32_16x16x32_bf16 v[84:87], v[48:51], v[36:39], v[84:87]
    v_mfma_f32_16x16x32_bf16 v[88:91], v[48:51], v[40:43], v[88:91]
    v_mfma_f32_16x16x32_bf16 v[92:95], v[48:51], v[44:47], v[92:95]
    ds_read_b64_tr_b16 v[48:49], v9 offset:21712
    s_waitcnt lgkmcnt(5)
    v_mfma_f32_16x16x32_bf16 v[96:99], v[52:55], v[32:35], v[96:99]
    ds_read_b64_tr_b16 v[50:51], v9 offset:25296
    v_mfma_f32_16x16x32_bf16 v[100:103], v[52:55], v[36:39], v[100:103]
    s_barrier
    ds_read_b64_tr_b16 v[16:17], v12 offset:0
    v_mfma_f32_16x16x32_bf16 v[104:107], v[52:55], v[40:43], v[104:107]
    ds_read_b64_tr_b16 v[18:19], v12 offset:4096
    v_mfma_f32_16x16x32_bf16 v[108:111], v[52:55], v[44:47], v[108:111]
    ds_read_b64_tr_b16 v[52:53], v11 offset:14464
    s_waitcnt lgkmcnt(7)
    v_mfma_f32_16x16x32_bf16 v[112:115], v[56:59], v[32:35], v[112:115]
    ds_read_b64_tr_b16 v[54:55], v11 offset:18048
    v_mfma_f32_16x16x32_bf16 v[116:119], v[56:59], v[36:39], v[116:119]
    ds_read_b64_tr_b16 v[20:21], v13 offset:0
    v_mfma_f32_16x16x32_bf16 v[120:123], v[56:59], v[40:43], v[120:123]
    ds_read_b64_tr_b16 v[22:23], v13 offset:4096
    v_mfma_f32_16x16x32_bf16 v[124:127], v[56:59], v[44:47], v[124:127]
    ds_read_b64_tr_b16 v[56:57], v9 offset:28928
    s_waitcnt lgkmcnt(9)
    v_mfma_f32_16x16x32_bf16 v[128:131], v[60:63], v[32:35], v[128:131]
    ds_read_b64_tr_b16 v[58:59], v9 offset:32512
    v_mfma_f32_16x16x32_bf16 v[132:135], v[60:63], v[36:39], v[132:135]
    ds_read_b64_tr_b16 v[24:25], v14 offset:0
    v_mfma_f32_16x16x32_bf16 v[136:139], v[60:63], v[40:43], v[136:139]
    ds_read_b64_tr_b16 v[26:27], v14 offset:4096
    v_mfma_f32_16x16x32_bf16 v[140:143], v[60:63], v[44:47], v[140:143]
    ds_read_b64_tr_b16 v[60:61], v9 offset:36112
    s_waitcnt lgkmcnt(11)
    v_mfma_f32_16x16x32_bf16 v[144:147], v[48:51], v[32:35], v[144:147]
    ds_read_b64_tr_b16 v[62:63], v9 offset:39696
    v_mfma_f32_16x16x32_bf16 v[148:151], v[48:51], v[36:39], v[148:151]
    ds_read_b64_tr_b16 v[28:29], v15 offset:0
    v_mfma_f32_16x16x32_bf16 v[152:155], v[48:51], v[40:43], v[152:155]
    ds_read_b64_tr_b16 v[30:31], v15 offset:4096
    v_mfma_f32_16x16x32_bf16 v[156:159], v[48:51], v[44:47], v[156:159]
    ds_read_b64_tr_b16 v[48:49], v9 offset:28960
    s_waitcnt lgkmcnt(11)
    v_mfma_f32_16x16x32_bf16 v[160:163], v[52:55], v[32:35], v[160:163]
    ds_read_b64_tr_b16 v[50:51], v9 offset:32544
    v_mfma_f32_16x16x32_bf16 v[164:167], v[52:55], v[36:39], v[164:167]
    v_mfma_f32_16x16x32_bf16 v[168:171], v[52:55], v[40:43], v[168:171]
    v_mfma_f32_16x16x32_bf16 v[172:175], v[52:55], v[44:47], v[172:175]
    ds_read_b64_tr_b16 v[52:53], v9 offset:36144
    s_waitcnt lgkmcnt(9)
    v_mfma_f32_16x16x32_bf16 v[64:67], v[56:59], v[16:19], v[64:67]
    ds_read_b64_tr_b16 v[54:55], v9 offset:39728
    v_mfma_f32_16x16x32_bf16 v[68:71], v[56:59], v[20:23], v[68:71]
    s_waitcnt lgkmcnt(8)
    v_mfma_f32_16x16x32_bf16 v[72:75], v[56:59], v[24:27], v[72:75]
    s_waitcnt lgkmcnt(4)
    v_mfma_f32_16x16x32_bf16 v[76:79], v[56:59], v[28:31], v[76:79]
    ds_read_b64_tr_b16 v[56:57], v9 offset:28992
    v_mfma_f32_16x16x32_bf16 v[80:83], v[60:63], v[16:19], v[80:83]
    ds_read_b64_tr_b16 v[58:59], v9 offset:32576
    v_mfma_f32_16x16x32_bf16 v[84:87], v[60:63], v[20:23], v[84:87]
    v_mfma_f32_16x16x32_bf16 v[88:91], v[60:63], v[24:27], v[88:91]
    v_mfma_f32_16x16x32_bf16 v[92:95], v[60:63], v[28:31], v[92:95]
    ds_read_b64_tr_b16 v[60:61], v9 offset:36176
    s_waitcnt lgkmcnt(5)
    v_mfma_f32_16x16x32_bf16 v[96:99], v[48:51], v[16:19], v[96:99]
    ds_read_b64_tr_b16 v[62:63], v9 offset:39760
    v_mfma_f32_16x16x32_bf16 v[100:103], v[48:51], v[20:23], v[100:103]
    s_barrier
    ds_read_b64_tr_b16 v[32:33], v12 offset:8192
    v_mfma_f32_16x16x32_bf16 v[104:107], v[48:51], v[24:27], v[104:107]
    ds_read_b64_tr_b16 v[34:35], v12 offset:12288
    v_mfma_f32_16x16x32_bf16 v[108:111], v[48:51], v[28:31], v[108:111]
    ds_read_b64_tr_b16 v[48:49], v11 offset:28928
    s_waitcnt lgkmcnt(7)
    v_mfma_f32_16x16x32_bf16 v[112:115], v[52:55], v[16:19], v[112:115]
    ds_read_b64_tr_b16 v[50:51], v11 offset:32512
    v_mfma_f32_16x16x32_bf16 v[116:119], v[52:55], v[20:23], v[116:119]
    ds_read_b64_tr_b16 v[36:37], v13 offset:8192
    v_mfma_f32_16x16x32_bf16 v[120:123], v[52:55], v[24:27], v[120:123]
    ds_read_b64_tr_b16 v[38:39], v13 offset:12288
    v_mfma_f32_16x16x32_bf16 v[124:127], v[52:55], v[28:31], v[124:127]
    ds_read_b64_tr_b16 v[52:53], v8 offset:0
    s_waitcnt lgkmcnt(9)
    v_mfma_f32_16x16x32_bf16 v[128:131], v[56:59], v[16:19], v[128:131]
    ds_read_b64_tr_b16 v[54:55], v8 offset:3584
    v_mfma_f32_16x16x32_bf16 v[132:135], v[56:59], v[20:23], v[132:135]
    ds_read_b64_tr_b16 v[40:41], v14 offset:8192
    v_mfma_f32_16x16x32_bf16 v[136:139], v[56:59], v[24:27], v[136:139]
    ds_read_b64_tr_b16 v[42:43], v14 offset:12288
    v_mfma_f32_16x16x32_bf16 v[140:143], v[56:59], v[28:31], v[140:143]
    ds_read_b64_tr_b16 v[56:57], v8 offset:7184
    s_waitcnt lgkmcnt(11)
    v_mfma_f32_16x16x32_bf16 v[144:147], v[60:63], v[16:19], v[144:147]
    ds_read_b64_tr_b16 v[58:59], v8 offset:10768
    v_mfma_f32_16x16x32_bf16 v[148:151], v[60:63], v[20:23], v[148:151]
    ds_read_b64_tr_b16 v[44:45], v15 offset:8192
    v_mfma_f32_16x16x32_bf16 v[152:155], v[60:63], v[24:27], v[152:155]
    ds_read_b64_tr_b16 v[46:47], v15 offset:12288
    v_mfma_f32_16x16x32_bf16 v[156:159], v[60:63], v[28:31], v[156:159]
    ds_read_b64_tr_b16 v[60:61], v8 offset:32
    s_waitcnt lgkmcnt(11)
    v_mfma_f32_16x16x32_bf16 v[160:163], v[48:51], v[16:19], v[160:163]
    ds_read_b64_tr_b16 v[62:63], v8 offset:3616
    v_mfma_f32_16x16x32_bf16 v[164:167], v[48:51], v[20:23], v[164:167]
    v_mfma_f32_16x16x32_bf16 v[168:171], v[48:51], v[24:27], v[168:171]
    v_mfma_f32_16x16x32_bf16 v[172:175], v[48:51], v[28:31], v[172:175]
    ds_read_b64_tr_b16 v[48:49], v8 offset:7216
    s_waitcnt lgkmcnt(9)
    v_mfma_f32_16x16x32_bf16 v[64:67], v[52:55], v[32:35], v[64:67]
    ds_read_b64_tr_b16 v[50:51], v8 offset:10800
    v_mfma_f32_16x16x32_bf16 v[68:71], v[52:55], v[36:39], v[68:71]
    s_waitcnt lgkmcnt(8)
    v_mfma_f32_16x16x32_bf16 v[72:75], v[52:55], v[40:43], v[72:75]
    s_waitcnt lgkmcnt(4)
    v_mfma_f32_16x16x32_bf16 v[76:79], v[52:55], v[44:47], v[76:79]
    ds_read_b64_tr_b16 v[52:53], v8 offset:64
    v_mfma_f32_16x16x32_bf16 v[80:83], v[56:59], v[32:35], v[80:83]
    ds_read_b64_tr_b16 v[54:55], v8 offset:3648
    v_mfma_f32_16x16x32_bf16 v[84:87], v[56:59], v[36:39], v[84:87]
    v_mfma_f32_16x16x32_bf16 v[88:91], v[56:59], v[40:43], v[88:91]
    v_mfma_f32_16x16x32_bf16 v[92:95], v[56:59], v[44:47], v[92:95]
    ds_read_b64_tr_b16 v[56:57], v8 offset:7248
    s_waitcnt lgkmcnt(5)
    v_mfma_f32_16x16x32_bf16 v[96:99], v[60:63], v[32:35], v[96:99]
    ds_read_b64_tr_b16 v[58:59], v8 offset:10832
    v_mfma_f32_16x16x32_bf16 v[100:103], v[60:63], v[36:39], v[100:103]
    s_barrier
    ds_read_b64_tr_b16 v[16:17], v12 offset:16384
    v_mfma_f32_16x16x32_bf16 v[104:107], v[60:63], v[40:43], v[104:107]
    ds_read_b64_tr_b16 v[18:19], v12 offset:20480
    v_mfma_f32_16x16x32_bf16 v[108:111], v[60:63], v[44:47], v[108:111]
    ds_read_b64_tr_b16 v[60:61], v10 offset:0
    s_waitcnt lgkmcnt(7)
    v_mfma_f32_16x16x32_bf16 v[112:115], v[48:51], v[32:35], v[112:115]
    ds_read_b64_tr_b16 v[62:63], v10 offset:3584
    v_mfma_f32_16x16x32_bf16 v[116:119], v[48:51], v[36:39], v[116:119]
    ds_read_b64_tr_b16 v[20:21], v13 offset:16384
    v_mfma_f32_16x16x32_bf16 v[120:123], v[48:51], v[40:43], v[120:123]
    ds_read_b64_tr_b16 v[22:23], v13 offset:20480
    v_mfma_f32_16x16x32_bf16 v[124:127], v[48:51], v[44:47], v[124:127]
    ds_read_b64_tr_b16 v[48:49], v8 offset:14464
    s_waitcnt lgkmcnt(9)
    v_mfma_f32_16x16x32_bf16 v[128:131], v[52:55], v[32:35], v[128:131]
    ds_read_b64_tr_b16 v[50:51], v8 offset:18048
    v_mfma_f32_16x16x32_bf16 v[132:135], v[52:55], v[36:39], v[132:135]
    ds_read_b64_tr_b16 v[24:25], v14 offset:16384
    v_mfma_f32_16x16x32_bf16 v[136:139], v[52:55], v[40:43], v[136:139]
    ds_read_b64_tr_b16 v[26:27], v14 offset:20480
    v_mfma_f32_16x16x32_bf16 v[140:143], v[52:55], v[44:47], v[140:143]
    ds_read_b64_tr_b16 v[52:53], v8 offset:21648
    s_waitcnt lgkmcnt(11)
    v_mfma_f32_16x16x32_bf16 v[144:147], v[56:59], v[32:35], v[144:147]
    ds_read_b64_tr_b16 v[54:55], v8 offset:25232
    v_mfma_f32_16x16x32_bf16 v[148:151], v[56:59], v[36:39], v[148:151]
    ds_read_b64_tr_b16 v[28:29], v15 offset:16384
    v_mfma_f32_16x16x32_bf16 v[152:155], v[56:59], v[40:43], v[152:155]
    ds_read_b64_tr_b16 v[30:31], v15 offset:20480
    v_mfma_f32_16x16x32_bf16 v[156:159], v[56:59], v[44:47], v[156:159]
    ds_read_b64_tr_b16 v[56:57], v8 offset:14496
    s_waitcnt lgkmcnt(11)
    v_mfma_f32_16x16x32_bf16 v[160:163], v[60:63], v[32:35], v[160:163]
    ds_read_b64_tr_b16 v[58:59], v8 offset:18080
    v_mfma_f32_16x16x32_bf16 v[164:167], v[60:63], v[36:39], v[164:167]
    v_mfma_f32_16x16x32_bf16 v[168:171], v[60:63], v[40:43], v[168:171]
    v_mfma_f32_16x16x32_bf16 v[172:175], v[60:63], v[44:47], v[172:175]
    ds_read_b64_tr_b16 v[60:61], v8 offset:21680
    s_waitcnt lgkmcnt(9)
    v_mfma_f32_16x16x32_bf16 v[64:67], v[48:51], v[16:19], v[64:67]
    ds_read_b64_tr_b16 v[62:63], v8 offset:25264
    v_mfma_f32_16x16x32_bf16 v[68:71], v[48:51], v[20:23], v[68:71]
    s_waitcnt lgkmcnt(8)
    v_mfma_f32_16x16x32_bf16 v[72:75], v[48:51], v[24:27], v[72:75]
    s_waitcnt lgkmcnt(4)
    v_mfma_f32_16x16x32_bf16 v[76:79], v[48:51], v[28:31], v[76:79]
    ds_read_b64_tr_b16 v[48:49], v8 offset:14528
    v_mfma_f32_16x16x32_bf16 v[80:83], v[52:55], v[16:19], v[80:83]
    ds_read_b64_tr_b16 v[50:51], v8 offset:18112
    v_mfma_f32_16x16x32_bf16 v[84:87], v[52:55], v[20:23], v[84:87]
    v_mfma_f32_16x16x32_bf16 v[88:91], v[52:55], v[24:27], v[88:91]
    v_mfma_f32_16x16x32_bf16 v[92:95], v[52:55], v[28:31], v[92:95]
    ds_read_b64_tr_b16 v[52:53], v8 offset:21712
    s_waitcnt lgkmcnt(5)
    v_mfma_f32_16x16x32_bf16 v[96:99], v[56:59], v[16:19], v[96:99]
    ds_read_b64_tr_b16 v[54:55], v8 offset:25296
    v_mfma_f32_16x16x32_bf16 v[100:103], v[56:59], v[20:23], v[100:103]
    s_barrier
    ds_read_b64_tr_b16 v[32:33], v12 offset:24576
    v_mfma_f32_16x16x32_bf16 v[104:107], v[56:59], v[24:27], v[104:107]
    ds_read_b64_tr_b16 v[34:35], v12 offset:28672
    v_mfma_f32_16x16x32_bf16 v[108:111], v[56:59], v[28:31], v[108:111]
    ds_read_b64_tr_b16 v[56:57], v10 offset:14464
    s_waitcnt lgkmcnt(7)
    v_mfma_f32_16x16x32_bf16 v[112:115], v[60:63], v[16:19], v[112:115]
    ds_read_b64_tr_b16 v[58:59], v10 offset:18048
    v_mfma_f32_16x16x32_bf16 v[116:119], v[60:63], v[20:23], v[116:119]
    ds_read_b64_tr_b16 v[36:37], v13 offset:24576
    v_mfma_f32_16x16x32_bf16 v[120:123], v[60:63], v[24:27], v[120:123]
    ds_read_b64_tr_b16 v[38:39], v13 offset:28672
    v_mfma_f32_16x16x32_bf16 v[124:127], v[60:63], v[28:31], v[124:127]
    ds_read_b64_tr_b16 v[60:61], v8 offset:28928
    s_waitcnt lgkmcnt(9)
    v_mfma_f32_16x16x32_bf16 v[128:131], v[48:51], v[16:19], v[128:131]
    ds_read_b64_tr_b16 v[62:63], v8 offset:32512
    v_mfma_f32_16x16x32_bf16 v[132:135], v[48:51], v[20:23], v[132:135]
    ds_read_b64_tr_b16 v[40:41], v14 offset:24576
    v_mfma_f32_16x16x32_bf16 v[136:139], v[48:51], v[24:27], v[136:139]
    ds_read_b64_tr_b16 v[42:43], v14 offset:28672
    v_mfma_f32_16x16x32_bf16 v[140:143], v[48:51], v[28:31], v[140:143]
    ds_read_b64_tr_b16 v[48:49], v8 offset:36112
    s_waitcnt lgkmcnt(11)
    v_mfma_f32_16x16x32_bf16 v[144:147], v[52:55], v[16:19], v[144:147]
    ds_read_b64_tr_b16 v[50:51], v8 offset:39696
    v_mfma_f32_16x16x32_bf16 v[148:151], v[52:55], v[20:23], v[148:151]
    ds_read_b64_tr_b16 v[44:45], v15 offset:24576
    v_mfma_f32_16x16x32_bf16 v[152:155], v[52:55], v[24:27], v[152:155]
    ds_read_b64_tr_b16 v[46:47], v15 offset:28672
    v_mfma_f32_16x16x32_bf16 v[156:159], v[52:55], v[28:31], v[156:159]
    ds_read_b64_tr_b16 v[52:53], v8 offset:28960
    s_waitcnt lgkmcnt(11)
    v_mfma_f32_16x16x32_bf16 v[160:163], v[56:59], v[16:19], v[160:163]
    ds_read_b64_tr_b16 v[54:55], v8 offset:32544
    v_mfma_f32_16x16x32_bf16 v[164:167], v[56:59], v[20:23], v[164:167]
    v_mfma_f32_16x16x32_bf16 v[168:171], v[56:59], v[24:27], v[168:171]
    v_mfma_f32_16x16x32_bf16 v[172:175], v[56:59], v[28:31], v[172:175]
    ds_read_b64_tr_b16 v[56:57], v8 offset:36144
    s_waitcnt lgkmcnt(9)
    v_mfma_f32_16x16x32_bf16 v[64:67], v[60:63], v[32:35], v[64:67]
    ds_read_b64_tr_b16 v[58:59], v8 offset:39728
    v_mfma_f32_16x16x32_bf16 v[68:71], v[60:63], v[36:39], v[68:71]
    s_waitcnt lgkmcnt(8)
    v_mfma_f32_16x16x32_bf16 v[72:75], v[60:63], v[40:43], v[72:75]
    s_waitcnt lgkmcnt(4)
    v_mfma_f32_16x16x32_bf16 v[76:79], v[60:63], v[44:47], v[76:79]
    ds_read_b64_tr_b16 v[60:61], v8 offset:28992
    v_mfma_f32_16x16x32_bf16 v[80:83], v[48:51], v[32:35], v[80:83]
    ds_read_b64_tr_b16 v[62:63], v8 offset:32576
    v_mfma_f32_16x16x32_bf16 v[84:87], v[48:51], v[36:39], v[84:87]
    v_mfma_f32_16x16x32_bf16 v[88:91], v[48:51], v[40:43], v[88:91]
    v_mfma_f32_16x16x32_bf16 v[92:95], v[48:51], v[44:47], v[92:95]
    ds_read_b64_tr_b16 v[48:49], v8 offset:36176
    s_waitcnt lgkmcnt(5)
    v_mfma_f32_16x16x32_bf16 v[96:99], v[52:55], v[32:35], v[96:99]
    ds_read_b64_tr_b16 v[50:51], v8 offset:39760
    v_mfma_f32_16x16x32_bf16 v[100:103], v[52:55], v[36:39], v[100:103]
    s_barrier
    ds_read_b64_tr_b16 v[16:17], v12 offset:32768
    v_mfma_f32_16x16x32_bf16 v[104:107], v[52:55], v[40:43], v[104:107]
    ds_read_b64_tr_b16 v[18:19], v12 offset:36864
    v_mfma_f32_16x16x32_bf16 v[108:111], v[52:55], v[44:47], v[108:111]
    ds_read_b64_tr_b16 v[52:53], v10 offset:28928
    s_waitcnt lgkmcnt(7)
    v_mfma_f32_16x16x32_bf16 v[112:115], v[56:59], v[32:35], v[112:115]
    ds_read_b64_tr_b16 v[54:55], v10 offset:32512
    v_mfma_f32_16x16x32_bf16 v[116:119], v[56:59], v[36:39], v[116:119]
    ds_read_b64_tr_b16 v[20:21], v13 offset:32768
    v_mfma_f32_16x16x32_bf16 v[120:123], v[56:59], v[40:43], v[120:123]
    ds_read_b64_tr_b16 v[22:23], v13 offset:36864
    v_mfma_f32_16x16x32_bf16 v[124:127], v[56:59], v[44:47], v[124:127]
    ds_read_b64_tr_b16 v[56:57], v8 offset:43392
    s_waitcnt lgkmcnt(9)
    v_mfma_f32_16x16x32_bf16 v[128:131], v[60:63], v[32:35], v[128:131]
    ds_read_b64_tr_b16 v[58:59], v8 offset:46976
    v_mfma_f32_16x16x32_bf16 v[132:135], v[60:63], v[36:39], v[132:135]
    ds_read_b64_tr_b16 v[24:25], v14 offset:32768
    v_mfma_f32_16x16x32_bf16 v[136:139], v[60:63], v[40:43], v[136:139]
    ds_read_b64_tr_b16 v[26:27], v14 offset:36864
    v_mfma_f32_16x16x32_bf16 v[140:143], v[60:63], v[44:47], v[140:143]
    ds_read_b64_tr_b16 v[60:61], v8 offset:50576
    s_waitcnt lgkmcnt(11)
    v_mfma_f32_16x16x32_bf16 v[144:147], v[48:51], v[32:35], v[144:147]
    ds_read_b64_tr_b16 v[62:63], v8 offset:54160
    v_mfma_f32_16x16x32_bf16 v[148:151], v[48:51], v[36:39], v[148:151]
    ds_read_b64_tr_b16 v[28:29], v15 offset:32768
    v_mfma_f32_16x16x32_bf16 v[152:155], v[48:51], v[40:43], v[152:155]
    ds_read_b64_tr_b16 v[30:31], v15 offset:36864
    v_mfma_f32_16x16x32_bf16 v[156:159], v[48:51], v[44:47], v[156:159]
    ds_read_b64_tr_b16 v[48:49], v8 offset:43424
    s_waitcnt lgkmcnt(11)
    v_mfma_f32_16x16x32_bf16 v[160:163], v[52:55], v[32:35], v[160:163]
    ds_read_b64_tr_b16 v[50:51], v8 offset:47008
    v_mfma_f32_16x16x32_bf16 v[164:167], v[52:55], v[36:39], v[164:167]
    v_mfma_f32_16x16x32_bf16 v[168:171], v[52:55], v[40:43], v[168:171]
    v_mfma_f32_16x16x32_bf16 v[172:175], v[52:55], v[44:47], v[172:175]
    ds_read_b64_tr_b16 v[52:53], v8 offset:50608
    s_waitcnt lgkmcnt(9)
    v_mfma_f32_16x16x32_bf16 v[64:67], v[56:59], v[16:19], v[64:67]
    ds_read_b64_tr_b16 v[54:55], v8 offset:54192
    v_mfma_f32_16x16x32_bf16 v[68:71], v[56:59], v[20:23], v[68:71]
    s_waitcnt lgkmcnt(8)
    v_mfma_f32_16x16x32_bf16 v[72:75], v[56:59], v[24:27], v[72:75]
    s_waitcnt lgkmcnt(4)
    v_mfma_f32_16x16x32_bf16 v[76:79], v[56:59], v[28:31], v[76:79]
    ds_read_b64_tr_b16 v[56:57], v8 offset:43456
    v_mfma_f32_16x16x32_bf16 v[80:83], v[60:63], v[16:19], v[80:83]
    ds_read_b64_tr_b16 v[58:59], v8 offset:47040
    v_mfma_f32_16x16x32_bf16 v[84:87], v[60:63], v[20:23], v[84:87]
    v_mfma_f32_16x16x32_bf16 v[88:91], v[60:63], v[24:27], v[88:91]
    v_mfma_f32_16x16x32_bf16 v[92:95], v[60:63], v[28:31], v[92:95]
    ds_read_b64_tr_b16 v[60:61], v8 offset:50640
    s_waitcnt lgkmcnt(5)
    v_mfma_f32_16x16x32_bf16 v[96:99], v[48:51], v[16:19], v[96:99]
    ds_read_b64_tr_b16 v[62:63], v8 offset:54224
    v_mfma_f32_16x16x32_bf16 v[100:103], v[48:51], v[20:23], v[100:103]
    s_barrier
    ds_read_b64_tr_b16 v[32:33], v12 offset:40960
    v_mfma_f32_16x16x32_bf16 v[104:107], v[48:51], v[24:27], v[104:107]
    ds_read_b64_tr_b16 v[34:35], v12 offset:45056
    v_mfma_f32_16x16x32_bf16 v[108:111], v[48:51], v[28:31], v[108:111]
    ds_read_b64_tr_b16 v[48:49], v10 offset:43392
    s_waitcnt lgkmcnt(7)
    v_mfma_f32_16x16x32_bf16 v[112:115], v[52:55], v[16:19], v[112:115]
    ds_read_b64_tr_b16 v[50:51], v10 offset:46976
    v_mfma_f32_16x16x32_bf16 v[116:119], v[52:55], v[20:23], v[116:119]
    ds_read_b64_tr_b16 v[36:37], v13 offset:40960
    v_mfma_f32_16x16x32_bf16 v[120:123], v[52:55], v[24:27], v[120:123]
    ds_read_b64_tr_b16 v[38:39], v13 offset:45056
    v_mfma_f32_16x16x32_bf16 v[124:127], v[52:55], v[28:31], v[124:127]
    ds_read_b64_tr_b16 v[52:53], v9 offset:0
    s_waitcnt lgkmcnt(9)
    v_mfma_f32_16x16x32_bf16 v[128:131], v[56:59], v[16:19], v[128:131]
    ds_read_b64_tr_b16 v[54:55], v9 offset:3584
    v_mfma_f32_16x16x32_bf16 v[132:135], v[56:59], v[20:23], v[132:135]
    ds_read_b64_tr_b16 v[40:41], v14 offset:40960
    v_mfma_f32_16x16x32_bf16 v[136:139], v[56:59], v[24:27], v[136:139]
    ds_read_b64_tr_b16 v[42:43], v14 offset:45056
    v_mfma_f32_16x16x32_bf16 v[140:143], v[56:59], v[28:31], v[140:143]
    ds_read_b64_tr_b16 v[56:57], v9 offset:7184
    s_waitcnt lgkmcnt(11)
    v_mfma_f32_16x16x32_bf16 v[144:147], v[60:63], v[16:19], v[144:147]
    ds_read_b64_tr_b16 v[58:59], v9 offset:10768
    v_mfma_f32_16x16x32_bf16 v[148:151], v[60:63], v[20:23], v[148:151]
    ds_read_b64_tr_b16 v[44:45], v15 offset:40960
    v_mfma_f32_16x16x32_bf16 v[152:155], v[60:63], v[24:27], v[152:155]
    ds_read_b64_tr_b16 v[46:47], v15 offset:45056
    v_mfma_f32_16x16x32_bf16 v[156:159], v[60:63], v[28:31], v[156:159]
    ds_read_b64_tr_b16 v[60:61], v9 offset:32
    s_waitcnt lgkmcnt(11)
    v_mfma_f32_16x16x32_bf16 v[160:163], v[48:51], v[16:19], v[160:163]
    ds_read_b64_tr_b16 v[62:63], v9 offset:3616
    v_mfma_f32_16x16x32_bf16 v[164:167], v[48:51], v[20:23], v[164:167]
    v_mfma_f32_16x16x32_bf16 v[168:171], v[48:51], v[24:27], v[168:171]
    v_mfma_f32_16x16x32_bf16 v[172:175], v[48:51], v[28:31], v[172:175]
    ds_read_b64_tr_b16 v[48:49], v9 offset:7216
    s_waitcnt lgkmcnt(9)
    v_mfma_f32_16x16x32_bf16 v[64:67], v[52:55], v[32:35], v[64:67]
    ds_read_b64_tr_b16 v[50:51], v9 offset:10800
    v_mfma_f32_16x16x32_bf16 v[68:71], v[52:55], v[36:39], v[68:71]
    s_waitcnt lgkmcnt(8)
    v_mfma_f32_16x16x32_bf16 v[72:75], v[52:55], v[40:43], v[72:75]
    s_waitcnt lgkmcnt(4)
    v_mfma_f32_16x16x32_bf16 v[76:79], v[52:55], v[44:47], v[76:79]
    ds_read_b64_tr_b16 v[52:53], v9 offset:64
    v_mfma_f32_16x16x32_bf16 v[80:83], v[56:59], v[32:35], v[80:83]
    ds_read_b64_tr_b16 v[54:55], v9 offset:3648
    v_mfma_f32_16x16x32_bf16 v[84:87], v[56:59], v[36:39], v[84:87]
    v_mfma_f32_16x16x32_bf16 v[88:91], v[56:59], v[40:43], v[88:91]
    v_mfma_f32_16x16x32_bf16 v[92:95], v[56:59], v[44:47], v[92:95]
    ds_read_b64_tr_b16 v[56:57], v9 offset:7248
    s_waitcnt lgkmcnt(5)
    v_mfma_f32_16x16x32_bf16 v[96:99], v[60:63], v[32:35], v[96:99]
    ds_read_b64_tr_b16 v[58:59], v9 offset:10832
    v_mfma_f32_16x16x32_bf16 v[100:103], v[60:63], v[36:39], v[100:103]
    s_barrier
    ds_read_b64_tr_b16 v[16:17], v12 offset:0
    v_mfma_f32_16x16x32_bf16 v[104:107], v[60:63], v[40:43], v[104:107]
    ds_read_b64_tr_b16 v[18:19], v12 offset:4096
    v_mfma_f32_16x16x32_bf16 v[108:111], v[60:63], v[44:47], v[108:111]
    ds_read_b64_tr_b16 v[60:61], v11 offset:0
    s_waitcnt lgkmcnt(7)
    v_mfma_f32_16x16x32_bf16 v[112:115], v[48:51], v[32:35], v[112:115]
    ds_read_b64_tr_b16 v[62:63], v11 offset:3584
    v_mfma_f32_16x16x32_bf16 v[116:119], v[48:51], v[36:39], v[116:119]
    ds_read_b64_tr_b16 v[20:21], v13 offset:0
    v_mfma_f32_16x16x32_bf16 v[120:123], v[48:51], v[40:43], v[120:123]
    ds_read_b64_tr_b16 v[22:23], v13 offset:4096
    v_mfma_f32_16x16x32_bf16 v[124:127], v[48:51], v[44:47], v[124:127]
    ds_read_b64_tr_b16 v[48:49], v9 offset:14464
    s_waitcnt lgkmcnt(9)
    v_mfma_f32_16x16x32_bf16 v[128:131], v[52:55], v[32:35], v[128:131]
    ds_read_b64_tr_b16 v[50:51], v9 offset:18048
    v_mfma_f32_16x16x32_bf16 v[132:135], v[52:55], v[36:39], v[132:135]
    ds_read_b64_tr_b16 v[24:25], v14 offset:0
    v_mfma_f32_16x16x32_bf16 v[136:139], v[52:55], v[40:43], v[136:139]
    ds_read_b64_tr_b16 v[26:27], v14 offset:4096
    v_mfma_f32_16x16x32_bf16 v[140:143], v[52:55], v[44:47], v[140:143]
    ds_read_b64_tr_b16 v[52:53], v9 offset:21648
    s_waitcnt lgkmcnt(11)
    v_mfma_f32_16x16x32_bf16 v[144:147], v[56:59], v[32:35], v[144:147]
    ds_read_b64_tr_b16 v[54:55], v9 offset:25232
    v_mfma_f32_16x16x32_bf16 v[148:151], v[56:59], v[36:39], v[148:151]
    ds_read_b64_tr_b16 v[28:29], v15 offset:0
    v_mfma_f32_16x16x32_bf16 v[152:155], v[56:59], v[40:43], v[152:155]
    ds_read_b64_tr_b16 v[30:31], v15 offset:4096
    v_mfma_f32_16x16x32_bf16 v[156:159], v[56:59], v[44:47], v[156:159]
    ds_read_b64_tr_b16 v[56:57], v9 offset:14496
    s_waitcnt lgkmcnt(11)
    v_mfma_f32_16x16x32_bf16 v[160:163], v[60:63], v[32:35], v[160:163]
    ds_read_b64_tr_b16 v[58:59], v9 offset:18080
    v_mfma_f32_16x16x32_bf16 v[164:167], v[60:63], v[36:39], v[164:167]
    v_mfma_f32_16x16x32_bf16 v[168:171], v[60:63], v[40:43], v[168:171]
    v_mfma_f32_16x16x32_bf16 v[172:175], v[60:63], v[44:47], v[172:175]
    ds_read_b64_tr_b16 v[60:61], v9 offset:21680
    s_waitcnt lgkmcnt(9)
    v_mfma_f32_16x16x32_bf16 v[64:67], v[48:51], v[16:19], v[64:67]
    ds_read_b64_tr_b16 v[62:63], v9 offset:25264
    v_mfma_f32_16x16x32_bf16 v[68:71], v[48:51], v[20:23], v[68:71]
    s_waitcnt lgkmcnt(8)
    v_mfma_f32_16x16x32_bf16 v[72:75], v[48:51], v[24:27], v[72:75]
    s_waitcnt lgkmcnt(4)
    v_mfma_f32_16x16x32_bf16 v[76:79], v[48:51], v[28:31], v[76:79]
    ds_read_b64_tr_b16 v[48:49], v9 offset:14528
    v_mfma_f32_16x16x32_bf16 v[80:83], v[52:55], v[16:19], v[80:83]
    ds_read_b64_tr_b16 v[50:51], v9 offset:18112
    v_mfma_f32_16x16x32_bf16 v[84:87], v[52:55], v[20:23], v[84:87]
    v_mfma_f32_16x16x32_bf16 v[88:91], v[52:55], v[24:27], v[88:91]
    v_mfma_f32_16x16x32_bf16 v[92:95], v[52:55], v[28:31], v[92:95]
    ds_read_b64_tr_b16 v[52:53], v9 offset:21712
    s_waitcnt lgkmcnt(5)
    v_mfma_f32_16x16x32_bf16 v[96:99], v[56:59], v[16:19], v[96:99]
    ds_read_b64_tr_b16 v[54:55], v9 offset:25296
    v_mfma_f32_16x16x32_bf16 v[100:103], v[56:59], v[20:23], v[100:103]
    s_barrier
    ds_read_b64_tr_b16 v[32:33], v12 offset:8192
    v_mfma_f32_16x16x32_bf16 v[104:107], v[56:59], v[24:27], v[104:107]
    ds_read_b64_tr_b16 v[34:35], v12 offset:12288
    v_mfma_f32_16x16x32_bf16 v[108:111], v[56:59], v[28:31], v[108:111]
    ds_read_b64_tr_b16 v[56:57], v11 offset:14464
    s_waitcnt lgkmcnt(7)
    v_mfma_f32_16x16x32_bf16 v[112:115], v[60:63], v[16:19], v[112:115]
    ds_read_b64_tr_b16 v[58:59], v11 offset:18048
    v_mfma_f32_16x16x32_bf16 v[116:119], v[60:63], v[20:23], v[116:119]
    ds_read_b64_tr_b16 v[36:37], v13 offset:8192
    v_mfma_f32_16x16x32_bf16 v[120:123], v[60:63], v[24:27], v[120:123]
    ds_read_b64_tr_b16 v[38:39], v13 offset:12288
    v_mfma_f32_16x16x32_bf16 v[124:127], v[60:63], v[28:31], v[124:127]
    ds_read_b64_tr_b16 v[60:61], v9 offset:28928
    s_waitcnt lgkmcnt(9)
    v_mfma_f32_16x16x32_bf16 v[128:131], v[48:51], v[16:19], v[128:131]
    ds_read_b64_tr_b16 v[62:63], v9 offset:32512
    v_mfma_f32_16x16x32_bf16 v[132:135], v[48:51], v[20:23], v[132:135]
    ds_read_b64_tr_b16 v[40:41], v14 offset:8192
    v_mfma_f32_16x16x32_bf16 v[136:139], v[48:51], v[24:27], v[136:139]
    ds_read_b64_tr_b16 v[42:43], v14 offset:12288
    v_mfma_f32_16x16x32_bf16 v[140:143], v[48:51], v[28:31], v[140:143]
    ds_read_b64_tr_b16 v[48:49], v9 offset:36112
    s_waitcnt lgkmcnt(11)
    v_mfma_f32_16x16x32_bf16 v[144:147], v[52:55], v[16:19], v[144:147]
    ds_read_b64_tr_b16 v[50:51], v9 offset:39696
    v_mfma_f32_16x16x32_bf16 v[148:151], v[52:55], v[20:23], v[148:151]
    ds_read_b64_tr_b16 v[44:45], v15 offset:8192
    v_mfma_f32_16x16x32_bf16 v[152:155], v[52:55], v[24:27], v[152:155]
    ds_read_b64_tr_b16 v[46:47], v15 offset:12288
    v_mfma_f32_16x16x32_bf16 v[156:159], v[52:55], v[28:31], v[156:159]
    ds_read_b64_tr_b16 v[52:53], v9 offset:28960
    s_waitcnt lgkmcnt(11)
    v_mfma_f32_16x16x32_bf16 v[160:163], v[56:59], v[16:19], v[160:163]
    ds_read_b64_tr_b16 v[54:55], v9 offset:32544
    v_mfma_f32_16x16x32_bf16 v[164:167], v[56:59], v[20:23], v[164:167]
    v_mfma_f32_16x16x32_bf16 v[168:171], v[56:59], v[24:27], v[168:171]
    buffer_load_dwordx4 v[216:219], v7, s[4:7], s67 offen offset:2048 sc1
    v_mfma_f32_16x16x32_bf16 v[172:175], v[56:59], v[28:31], v[172:175]
    ds_read_b64_tr_b16 v[56:57], v9 offset:36144
    s_waitcnt lgkmcnt(9)
    v_mfma_f32_16x16x32_bf16 v[64:67], v[60:63], v[32:35], v[64:67]
    ds_read_b64_tr_b16 v[58:59], v9 offset:39728
    v_mfma_f32_16x16x32_bf16 v[68:71], v[60:63], v[36:39], v[68:71]
    s_waitcnt lgkmcnt(8)
    v_mfma_f32_16x16x32_bf16 v[72:75], v[60:63], v[40:43], v[72:75]
    s_waitcnt lgkmcnt(4)
    v_mfma_f32_16x16x32_bf16 v[76:79], v[60:63], v[44:47], v[76:79]
    ds_read_b64_tr_b16 v[60:61], v9 offset:28992
    v_mfma_f32_16x16x32_bf16 v[80:83], v[48:51], v[32:35], v[80:83]
    ds_read_b64_tr_b16 v[62:63], v9 offset:32576
    v_mfma_f32_16x16x32_bf16 v[84:87], v[48:51], v[36:39], v[84:87]
    v_mfma_f32_16x16x32_bf16 v[88:91], v[48:51], v[40:43], v[88:91]
    buffer_load_dwordx4 v[220:223], v7, s[4:7], s67 offen offset:3072 sc1
    v_mfma_f32_16x16x32_bf16 v[92:95], v[48:51], v[44:47], v[92:95]
    ds_read_b64_tr_b16 v[48:49], v9 offset:36176
    s_waitcnt lgkmcnt(5)
    v_mfma_f32_16x16x32_bf16 v[96:99], v[52:55], v[32:35], v[96:99]
    ds_read_b64_tr_b16 v[50:51], v9 offset:39760
    v_mfma_f32_16x16x32_bf16 v[100:103], v[52:55], v[36:39], v[100:103]
    s_barrier
    ds_read_b64_tr_b16 v[16:17], v12 offset:16384
    v_mfma_f32_16x16x32_bf16 v[104:107], v[52:55], v[40:43], v[104:107]
    ds_read_b64_tr_b16 v[18:19], v12 offset:20480
    v_mfma_f32_16x16x32_bf16 v[108:111], v[52:55], v[44:47], v[108:111]
    ds_read_b64_tr_b16 v[52:53], v11 offset:28928
    s_waitcnt lgkmcnt(7)
    v_mfma_f32_16x16x32_bf16 v[112:115], v[56:59], v[32:35], v[112:115]
    ds_read_b64_tr_b16 v[54:55], v11 offset:32512
    v_mfma_f32_16x16x32_bf16 v[116:119], v[56:59], v[36:39], v[116:119]
    ds_read_b64_tr_b16 v[20:21], v13 offset:16384
    v_mfma_f32_16x16x32_bf16 v[120:123], v[56:59], v[40:43], v[120:123]
    ds_read_b64_tr_b16 v[22:23], v13 offset:20480
    s_add_u32 s67, s67, 4096
    buffer_load_dwordx4 v[224:227], v7, s[4:7], s67 offen offset:0 sc1
    v_mfma_f32_16x16x32_bf16 v[124:127], v[56:59], v[44:47], v[124:127]
    ds_read_b64_tr_b16 v[56:57], v8 offset:0
    s_waitcnt lgkmcnt(9)
    v_mfma_f32_16x16x32_bf16 v[128:131], v[60:63], v[32:35], v[128:131]
    ds_read_b64_tr_b16 v[58:59], v8 offset:3584
    v_mfma_f32_16x16x32_bf16 v[132:135], v[60:63], v[36:39], v[132:135]
    ds_read_b64_tr_b16 v[24:25], v14 offset:16384
    v_mfma_f32_16x16x32_bf16 v[136:139], v[60:63], v[40:43], v[136:139]
    ds_read_b64_tr_b16 v[26:27], v14 offset:20480
    v_mfma_f32_16x16x32_bf16 v[140:143], v[60:63], v[44:47], v[140:143]
    ds_read_b64_tr_b16 v[60:61], v8 offset:7184
    s_waitcnt lgkmcnt(11)
    v_mfma_f32_16x16x32_bf16 v[144:147], v[48:51], v[32:35], v[144:147]
    ds_read_b64_tr_b16 v[62:63], v8 offset:10768
    v_mfma_f32_16x16x32_bf16 v[148:151], v[48:51], v[36:39], v[148:151]
    ds_read_b64_tr_b16 v[28:29], v15 offset:16384
    v_mfma_f32_16x16x32_bf16 v[152:155], v[48:51], v[40:43], v[152:155]
    ds_read_b64_tr_b16 v[30:31], v15 offset:20480
    buffer_load_dwordx4 v[228:231], v7, s[4:7], s67 offen offset:1024 sc1
    v_mfma_f32_16x16x32_bf16 v[156:159], v[48:51], v[44:47], v[156:159]
    ds_read_b64_tr_b16 v[48:49], v8 offset:32
    s_waitcnt lgkmcnt(11)
    v_mfma_f32_16x16x32_bf16 v[160:163], v[52:55], v[32:35], v[160:163]
    ds_read_b64_tr_b16 v[50:51], v8 offset:3616
    v_mfma_f32_16x16x32_bf16 v[164:167], v[52:55], v[36:39], v[164:167]
    v_mfma_f32_16x16x32_bf16 v[168:171], v[52:55], v[40:43], v[168:171]
    v_mfma_f32_16x16x32_bf16 v[172:175], v[52:55], v[44:47], v[172:175]
    ds_read_b64_tr_b16 v[52:53], v8 offset:7216
    s_waitcnt lgkmcnt(9)
    v_mfma_f32_16x16x32_bf16 v[64:67], v[56:59], v[16:19], v[64:67]
    ds_read_b64_tr_b16 v[54:55], v8 offset:10800
    v_mfma_f32_16x16x32_bf16 v[68:71], v[56:59], v[20:23], v[68:71]
    s_waitcnt lgkmcnt(8)
    v_mfma_f32_16x16x32_bf16 v[72:75], v[56:59], v[24:27], v[72:75]
    buffer_load_dwordx4 v[232:235], v7, s[4:7], s67 offen offset:2048 sc1
    s_waitcnt lgkmcnt(4)
    v_mfma_f32_16x16x32_bf16 v[76:79], v[56:59], v[28:31], v[76:79]
    ds_read_b64_tr_b16 v[56:57], v8 offset:64
    v_mfma_f32_16x16x32_bf16 v[80:83], v[60:63], v[16:19], v[80:83]
    ds_read_b64_tr_b16 v[58:59], v8 offset:3648
    v_mfma_f32_16x16x32_bf16 v[84:87], v[60:63], v[20:23], v[84:87]
    v_mfma_f32_16x16x32_bf16 v[88:91], v[60:63], v[24:27], v[88:91]
    v_mfma_f32_16x16x32_bf16 v[92:95], v[60:63], v[28:31], v[92:95]
    ds_read_b64_tr_b16 v[60:61], v8 offset:7248
    s_waitcnt lgkmcnt(5)
    v_mfma_f32_16x16x32_bf16 v[96:99], v[48:51], v[16:19], v[96:99]
    ds_read_b64_tr_b16 v[62:63], v8 offset:10832
    v_mfma_f32_16x16x32_bf16 v[100:103], v[48:51], v[20:23], v[100:103]
    s_barrier
    ds_read_b64_tr_b16 v[32:33], v12 offset:24576
    v_mfma_f32_16x16x32_bf16 v[104:107], v[48:51], v[24:27], v[104:107]
    ds_read_b64_tr_b16 v[34:35], v12 offset:28672
    buffer_load_dwordx4 v[236:239], v7, s[4:7], s67 offen offset:3072 sc1
    v_mfma_f32_16x16x32_bf16 v[108:111], v[48:51], v[28:31], v[108:111]
    ds_read_b64_tr_b16 v[48:49], v10 offset:0
    s_waitcnt lgkmcnt(7)
    v_mfma_f32_16x16x32_bf16 v[112:115], v[52:55], v[16:19], v[112:115]
    ds_read_b64_tr_b16 v[50:51], v10 offset:3584
    v_mfma_f32_16x16x32_bf16 v[116:119], v[52:55], v[20:23], v[116:119]
    ds_read_b64_tr_b16 v[36:37], v13 offset:24576
    v_mfma_f32_16x16x32_bf16 v[120:123], v[52:55], v[24:27], v[120:123]
    ds_read_b64_tr_b16 v[38:39], v13 offset:28672
    v_mfma_f32_16x16x32_bf16 v[124:127], v[52:55], v[28:31], v[124:127]
    ds_read_b64_tr_b16 v[52:53], v8 offset:14464
    s_waitcnt lgkmcnt(9)
    v_mfma_f32_16x16x32_bf16 v[128:131], v[56:59], v[16:19], v[128:131]
    ds_read_b64_tr_b16 v[54:55], v8 offset:18048
    v_mfma_f32_16x16x32_bf16 v[132:135], v[56:59], v[20:23], v[132:135]
    ds_read_b64_tr_b16 v[40:41], v14 offset:24576
    v_mfma_f32_16x16x32_bf16 v[136:139], v[56:59], v[24:27], v[136:139]
    ds_read_b64_tr_b16 v[42:43], v14 offset:28672
    s_add_u32 s67, s67, 4096
    buffer_load_dwordx4 v[240:243], v7, s[4:7], s67 offen offset:0 sc1
    v_mfma_f32_16x16x32_bf16 v[140:143], v[56:59], v[28:31], v[140:143]
    ds_read_b64_tr_b16 v[56:57], v8 offset:21648
    s_waitcnt lgkmcnt(11)
    v_mfma_f32_16x16x32_bf16 v[144:147], v[60:63], v[16:19], v[144:147]
    ds_read_b64_tr_b16 v[58:59], v8 offset:25232
    v_mfma_f32_16x16x32_bf16 v[148:151], v[60:63], v[20:23], v[148:151]
    ds_read_b64_tr_b16 v[44:45], v15 offset:24576
    v_mfma_f32_16x16x32_bf16 v[152:155], v[60:63], v[24:27], v[152:155]
    ds_read_b64_tr_b16 v[46:47], v15 offset:28672
    v_mfma_f32_16x16x32_bf16 v[156:159], v[60:63], v[28:31], v[156:159]
    ds_read_b64_tr_b16 v[60:61], v8 offset:14496
    s_waitcnt lgkmcnt(11)
    v_mfma_f32_16x16x32_bf16 v[160:163], v[48:51], v[16:19], v[160:163]
    ds_read_b64_tr_b16 v[62:63], v8 offset:18080
    v_mfma_f32_16x16x32_bf16 v[164:167], v[48:51], v[20:23], v[164:167]
    v_mfma_f32_16x16x32_bf16 v[168:171], v[48:51], v[24:27], v[168:171]
    buffer_load_dwordx4 v[244:247], v7, s[4:7], s67 offen offset:1024 sc1
    v_mfma_f32_16x16x32_bf16 v[172:175], v[48:51], v[28:31], v[172:175]
    ds_read_b64_tr_b16 v[48:49], v8 offset:21680
    s_waitcnt lgkmcnt(9)
    v_mfma_f32_16x16x32_bf16 v[64:67], v[52:55], v[32:35], v[64:67]
    ds_read_b64_tr_b16 v[50:51], v8 offset:25264
    v_mfma_f32_16x16x32_bf16 v[68:71], v[52:55], v[36:39], v[68:71]
    s_waitcnt lgkmcnt(8)
    v_mfma_f32_16x16x32_bf16 v[72:75], v[52:55], v[40:43], v[72:75]
    s_waitcnt lgkmcnt(4)
    v_mfma_f32_16x16x32_bf16 v[76:79], v[52:55], v[44:47], v[76:79]
    ds_read_b64_tr_b16 v[52:53], v8 offset:14528
    v_mfma_f32_16x16x32_bf16 v[80:83], v[56:59], v[32:35], v[80:83]
    ds_read_b64_tr_b16 v[54:55], v8 offset:18112
    v_mfma_f32_16x16x32_bf16 v[84:87], v[56:59], v[36:39], v[84:87]
    v_mfma_f32_16x16x32_bf16 v[88:91], v[56:59], v[40:43], v[88:91]
    buffer_load_dwordx4 v[248:251], v7, s[4:7], s67 offen offset:2048 sc1
    v_mfma_f32_16x16x32_bf16 v[92:95], v[56:59], v[44:47], v[92:95]
    ds_read_b64_tr_b16 v[56:57], v8 offset:21712
    s_waitcnt lgkmcnt(5)
    v_mfma_f32_16x16x32_bf16 v[96:99], v[60:63], v[32:35], v[96:99]
    ds_read_b64_tr_b16 v[58:59], v8 offset:25296
    v_mfma_f32_16x16x32_bf16 v[100:103], v[60:63], v[36:39], v[100:103]
    ds_read_b64 v[16:17], v6 offset:0
    v_mov_b32 v18, 0
    v_mov_b32 v19, 0
    v_mfma_f32_16x16x32_bf16 v[104:107], v[60:63], v[40:43], v[104:107]
    v_mfma_f32_16x16x32_bf16 v[108:111], v[60:63], v[44:47], v[108:111]
    ds_read_b64_tr_b16 v[60:61], v10 offset:14464
    s_waitcnt lgkmcnt(6)
    v_mfma_f32_16x16x32_bf16 v[112:115], v[48:51], v[32:35], v[112:115]
    ds_read_b64_tr_b16 v[62:63], v10 offset:18048
    v_mfma_f32_16x16x32_bf16 v[116:119], v[48:51], v[36:39], v[116:119]
    ds_read_b64 v[20:21], v6 offset:256
    v_mov_b32 v22, 0
    v_mov_b32 v23, 0
    v_mfma_f32_16x16x32_bf16 v[120:123], v[48:51], v[40:43], v[120:123]
    buffer_load_dwordx4 v[252:255], v7, s[4:7], s67 offen offset:3072 sc1
    v_mfma_f32_16x16x32_bf16 v[124:127], v[48:51], v[44:47], v[124:127]
    ds_read_b128 v[48:51], v4 offset:0
    s_waitcnt lgkmcnt(7)
    v_mfma_f32_16x16x32_bf16 v[128:131], v[52:55], v[32:35], v[128:131]
    v_mfma_f32_16x16x32_bf16 v[132:135], v[52:55], v[36:39], v[132:135]
    ds_read_b64 v[24:25], v6 offset:512
    v_mov_b32 v26, 0
    v_mov_b32 v27, 0
    v_mfma_f32_16x16x32_bf16 v[136:139], v[52:55], v[40:43], v[136:139]
    v_mfma_f32_16x16x32_bf16 v[140:143], v[52:55], v[44:47], v[140:143]
    ds_read_b128 v[52:55], v4 offset:256
    s_waitcnt lgkmcnt(7)
    v_mfma_f32_16x16x32_bf16 v[144:147], v[56:59], v[32:35], v[144:147]
    v_mfma_f32_16x16x32_bf16 v[148:151], v[56:59], v[36:39], v[148:151]
    ds_read_b64 v[28:29], v6 offset:768
    v_mov_b32 v30, 0
    v_mov_b32 v31, 0
    v_mfma_f32_16x16x32_bf16 v[152:155], v[56:59], v[40:43], v[152:155]
    v_mfma_f32_16x16x32_bf16 v[156:159], v[56:59], v[44:47], v[156:159]
    ds_read_b128 v[56:59], v4 offset:512
    s_waitcnt lgkmcnt(6)
    v_mfma_f32_16x16x32_bf16 v[160:163], v[60:63], v[32:35], v[160:163]
    v_mfma_f32_16x16x32_bf16 v[164:167], v[60:63], v[36:39], v[164:167]
    v_mfma_f32_16x16x32_bf16 v[168:171], v[60:63], v[40:43], v[168:171]
    v_mfma_f32_16x16x32_bf16 v[172:175], v[60:63], v[44:47], v[172:175]
    ds_read_b128 v[60:63], v4 offset:768
    s_waitcnt lgkmcnt(5)
    v_cndmask_b32 v16, 0, v16, s[56:57]
    v_cndmask_b32 v17, 0, v17, s[56:57]
    s_nop 1
    v_mfma_f32_16x16x32_bf16 v[64:67], v[48:51], v[16:19], v[64:67]
    v_cndmask_b32 v20, 0, v20, s[56:57]
    v_cndmask_b32 v21, 0, v21, s[56:57]
    s_nop 1
    v_mfma_f32_16x16x32_bf16 v[68:71], v[48:51], v[20:23], v[68:71]
    s_waitcnt lgkmcnt(4)
    v_cndmask_b32 v24, 0, v24, s[56:57]
    v_cndmask_b32 v25, 0, v25, s[56:57]
    s_nop 1
    v_mfma_f32_16x16x32_bf16 v[72:75], v[48:51], v[24:27], v[72:75]
    s_waitcnt lgkmcnt(2)
    v_cndmask_b32 v28, 0, v28, s[56:57]
    v_cndmask_b32 v29, 0, v29, s[56:57]
    s_nop 1
    v_mfma_f32_16x16x32_bf16 v[76:79], v[48:51], v[28:31], v[76:79]
    ds_read_b128 v[48:51], v4 offset:1024
    v_mfma_f32_16x16x32_bf16 v[80:83], v[52:55], v[16:19], v[80:83]
    ds_read_b64 v[32:33], v6 offset:8
    v_mfma_f32_16x16x32_bf16 v[84:87], v[52:55], v[20:23], v[84:87]
    ds_read_b64 v[34:35], v6 offset:264
    v_mfma_f32_16x16x32_bf16 v[88:91], v[52:55], v[24:27], v[88:91]
    ds_read_b64 v[36:37], v6 offset:520
    v_mfma_f32_16x16x32_bf16 v[92:95], v[52:55], v[28:31], v[92:95]
    ds_read_b64 v[38:39], v6 offset:776
    ds_read_b64 v[40:41], v1 offset:8
    ds_read_b128 v[52:55], v4 offset:1280
    s_waitcnt lgkmcnt(8)
    v_mfma_f32_16x16x32_bf16 v[96:99], v[56:59], v[16:19], v[96:99]
    v_mfma_f32_16x16x32_bf16 v[100:103], v[56:59], v[20:23], v[100:103]
    v_mfma_f32_16x16x32_bf16 v[104:107], v[56:59], v[24:27], v[104:107]
    v_mfma_f32_16x16x32_bf16 v[108:111], v[56:59], v[28:31], v[108:111]
    ds_read_b128 v[56:59], v5
    s_waitcnt lgkmcnt(8)
    v_mfma_f32_16x16x32_bf16 v[112:115], v[60:63], v[16:19], v[112:115]
    v_mfma_f32_16x16x32_bf16 v[116:119], v[60:63], v[20:23], v[116:119]
    v_mfma_f32_16x16x32_bf16 v[120:123], v[60:63], v[24:27], v[120:123]
    v_mfma_f32_16x16x32_bf16 v[124:127], v[60:63], v[28:31], v[124:127]
    s_waitcnt lgkmcnt(7)
    v_mfma_f32_16x16x32_bf16 v[128:131], v[48:51], v[16:19], v[128:131]
    v_mfma_f32_16x16x32_bf16 v[132:135], v[48:51], v[20:23], v[132:135]
    v_mfma_f32_16x16x32_bf16 v[136:139], v[48:51], v[24:27], v[136:139]
    v_mfma_f32_16x16x32_bf16 v[140:143], v[48:51], v[28:31], v[140:143]
    s_waitcnt lgkmcnt(1)
    v_mfma_f32_16x16x32_bf16 v[144:147], v[52:55], v[16:19], v[144:147]
    v_mfma_f32_16x16x32_bf16 v[148:151], v[52:55], v[20:23], v[148:151]
    v_mfma_f32_16x16x32_bf16 v[152:155], v[52:55], v[24:27], v[152:155]
    v_mfma_f32_16x16x32_bf16 v[156:159], v[52:55], v[28:31], v[156:159]
    s_waitcnt lgkmcnt(0)
    v_mfma_f32_16x16x32_bf16 v[160:163], v[56:59], v[16:19], v[160:163]
    v_mfma_f32_16x16x32_bf16 v[164:167], v[56:59], v[20:23], v[164:167]
    v_mfma_f32_16x16x32_bf16 v[168:171], v[56:59], v[24:27], v[168:171]
    v_mfma_f32_16x16x32_bf16 v[172:175], v[56:59], v[28:31], v[172:175]
    v_add_u32 v6, 114688, v7
    v_and_b32 v4, 31, v2
    v_lshlrev_b32 v4, 4, v4
    v_lshrrev_b32 v5, 5, v2
    v_mul_u32_u24 v5, 114688, v5
    v_add_u32 v4, v4, v5
    s_waitcnt lgkmcnt(0)
    v_pk_mul_f32 v[64:65], v[64:65], v[32:33] op_sel_hi:[1,0]
    v_pk_mul_f32 v[66:67], v[66:67], v[32:33] op_sel_hi:[1,0]
    v_pk_mul_f32 v[68:69], v[68:69], v[34:35] op_sel_hi:[1,0]
    v_pk_mul_f32 v[70:71], v[70:71], v[34:35] op_sel_hi:[1,0]
    v_exp_f32 v64, v64
    v_exp_f32 v65, v65
    v_exp_f32 v66, v66
    v_exp_f32 v67, v67
    v_exp_f32 v68, v68
    v_exp_f32 v69, v69
    v_exp_f32 v70, v70
    v_exp_f32 v71, v71
    v_pk_fma_f32 v[64:65], v[64:65], v[32:33], v[32:33] op_sel:[0,1,1] op_sel_hi:[1,1,1]
    v_pk_fma_f32 v[66:67], v[66:67], v[32:33], v[32:33] op_sel:[0,1,1] op_sel_hi:[1,1,1]
    v_pk_fma_f32 v[68:69], v[68:69], v[34:35], v[34:35] op_sel:[0,1,1] op_sel_hi:[1,1,1]
    v_pk_fma_f32 v[70:71], v[70:71], v[34:35], v[34:35] op_sel:[0,1,1] op_sel_hi:[1,1,1]
    v_rcp_f32 v64, v64
    v_rcp_f32 v65, v65
    v_rcp_f32 v66, v66
    v_rcp_f32 v67, v67
    v_rcp_f32 v68, v68
    v_rcp_f32 v69, v69
    v_rcp_f32 v70, v70
    v_rcp_f32 v71, v71
    v_pk_mul_f32 v[64:65], v[64:65], v[80:81]
    v_pk_mul_f32 v[66:67], v[66:67], v[82:83]
    v_pk_mul_f32 v[68:69], v[68:69], v[84:85]
    v_pk_mul_f32 v[70:71], v[70:71], v[86:87]
    v_cvt_pk_bf16_f32 v48, v64, v65
    v_cvt_pk_bf16_f32 v49, v66, v67
    v_cvt_pk_bf16_f32 v50, v68, v69
    v_cvt_pk_bf16_f32 v51, v70, v71
    s_nop 0
    v_permlane16_swap_b32 v48, v50
    v_permlane16_swap_b32 v49, v51
    buffer_store_dwordx4 v[48:51], v7, s[4:7], s70 offen offset:0 sc1
    v_pk_mul_f32 v[72:73], v[72:73], v[36:37] op_sel_hi:[1,0]
    v_pk_mul_f32 v[74:75], v[74:75], v[36:37] op_sel_hi:[1,0]
    v_pk_mul_f32 v[76:77], v[76:77], v[38:39] op_sel_hi:[1,0]
    v_pk_mul_f32 v[78:79], v[78:79], v[38:39] op_sel_hi:[1,0]
    v_exp_f32 v72, v72
    v_exp_f32 v73, v73
    v_exp_f32 v74, v74
    v_exp_f32 v75, v75
    v_exp_f32 v76, v76
    v_exp_f32 v77, v77
    v_exp_f32 v78, v78
    v_exp_f32 v79, v79
    v_pk_fma_f32 v[72:73], v[72:73], v[36:37], v[36:37] op_sel:[0,1,1] op_sel_hi:[1,1,1]
    v_pk_fma_f32 v[74:75], v[74:75], v[36:37], v[36:37] op_sel:[0,1,1] op_sel_hi:[1,1,1]
    v_pk_fma_f32 v[76:77], v[76:77], v[38:39], v[38:39] op_sel:[0,1,1] op_sel_hi:[1,1,1]
    v_pk_fma_f32 v[78:79], v[78:79], v[38:39], v[38:39] op_sel:[0,1,1] op_sel_hi:[1,1,1]
    v_rcp_f32 v72, v72
    v_rcp_f32 v73, v73
    v_rcp_f32 v74, v74
    v_rcp_f32 v75, v75
    v_rcp_f32 v76, v76
    v_rcp_f32 v77, v77
    v_rcp_f32 v78, v78
    v_rcp_f32 v79, v79
    v_pk_mul_f32 v[72:73], v[72:73], v[88:89]
    v_pk_mul_f32 v[74:75], v[74:75], v[90:91]
    v_pk_mul_f32 v[76:77], v[76:77], v[92:93]
    v_pk_mul_f32 v[78:79], v[78:79], v[94:95]
    v_cvt_pk_bf16_f32 v52, v72, v73
    v_cvt_pk_bf16_f32 v53, v74, v75
    v_cvt_pk_bf16_f32 v54, v76, v77
    v_cvt_pk_bf16_f32 v55, v78, v79
    s_nop 0
    v_permlane16_swap_b32 v52, v54
    v_permlane16_swap_b32 v53, v55
    buffer_store_dwordx4 v[52:55], v6, s[4:7], s70 offen offset:0 sc1
    v_permlane32_swap_b32 v160, v168
    v_permlane32_swap_b32 v164, v172
    v_permlane32_swap_b32 v161, v169
    v_permlane32_swap_b32 v165, v173
    v_permlane32_swap_b32 v162, v170
    v_permlane32_swap_b32 v166, v174
    v_permlane32_swap_b32 v163, v171
    v_permlane32_swap_b32 v167, v175
    v_permlane16_swap_b32 v160, v164
    v_permlane16_swap_b32 v168, v172
    v_permlane16_swap_b32 v161, v165
    v_permlane16_swap_b32 v169, v173
    v_permlane16_swap_b32 v162, v166
    v_permlane16_swap_b32 v170, v174
    v_permlane16_swap_b32 v163, v167
    v_permlane16_swap_b32 v171, v175
    v_pk_mul_f32 v[96:97], v[96:97], v[32:33] op_sel_hi:[1,0]
    v_pk_mul_f32 v[98:99], v[98:99], v[32:33] op_sel_hi:[1,0]
    v_pk_mul_f32 v[100:101], v[100:101], v[34:35] op_sel_hi:[1,0]
    v_pk_mul_f32 v[102:103], v[102:103], v[34:35] op_sel_hi:[1,0]
    v_exp_f32 v96, v96
    v_exp_f32 v97, v97
    v_exp_f32 v98, v98
    v_exp_f32 v99, v99
    v_exp_f32 v100, v100
    v_exp_f32 v101, v101
    v_exp_f32 v102, v102
    v_exp_f32 v103, v103
    v_pk_fma_f32 v[96:97], v[96:97], v[32:33], v[32:33] op_sel:[0,1,1] op_sel_hi:[1,1,1]
    v_pk_fma_f32 v[98:99], v[98:99], v[32:33], v[32:33] op_sel:[0,1,1] op_sel_hi:[1,1,1]
    v_pk_fma_f32 v[100:101], v[100:101], v[34:35], v[34:35] op_sel:[0,1,1] op_sel_hi:[1,1,1]
    v_pk_fma_f32 v[102:103], v[102:103], v[34:35], v[34:35] op_sel:[0,1,1] op_sel_hi:[1,1,1]
    v_rcp_f32 v96, v96
    v_rcp_f32 v97, v97
    v_rcp_f32 v98, v98
    v_rcp_f32 v99, v99
    v_rcp_f32 v100, v100
    v_rcp_f32 v101, v101
    v_rcp_f32 v102, v102
    v_rcp_f32 v103, v103
    v_pk_mul_f32 v[96:97], v[96:97], v[112:113]
    v_pk_mul_f32 v[98:99], v[98:99], v[114:115]
    v_pk_mul_f32 v[100:101], v[100:101], v[116:117]
    v_pk_mul_f32 v[102:103], v[102:103], v[118:119]
    v_cvt_pk_bf16_f32 v56, v96, v97
    v_cvt_pk_bf16_f32 v57, v98, v99
    v_cvt_pk_bf16_f32 v58, v100, v101
    v_cvt_pk_bf16_f32 v59, v102, v103
    s_nop 0
    v_permlane16_swap_b32 v56, v58
    v_permlane16_swap_b32 v57, v59
    buffer_store_dwordx4 v[56:59], v7, s[4:7], s70 offen offset:1024 sc1
    v_pk_mul_f32 v[104:105], v[104:105], v[36:37] op_sel_hi:[1,0]
    v_pk_mul_f32 v[106:107], v[106:107], v[36:37] op_sel_hi:[1,0]
    v_pk_mul_f32 v[108:109], v[108:109], v[38:39] op_sel_hi:[1,0]
    v_pk_mul_f32 v[110:111], v[110:111], v[38:39] op_sel_hi:[1,0]
    v_exp_f32 v104, v104
    v_exp_f32 v105, v105
    v_exp_f32 v106, v106
    v_exp_f32 v107, v107
    v_exp_f32 v108, v108
    v_exp_f32 v109, v109
    v_exp_f32 v110, v110
    v_exp_f32 v111, v111
    v_pk_fma_f32 v[104:105], v[104:105], v[36:37], v[36:37] op_sel:[0,1,1] op_sel_hi:[1,1,1]
    v_pk_fma_f32 v[106:107], v[106:107], v[36:37], v[36:37] op_sel:[0,1,1] op_sel_hi:[1,1,1]
    v_pk_fma_f32 v[108:109], v[108:109], v[38:39], v[38:39] op_sel:[0,1,1] op_sel_hi:[1,1,1]
    v_pk_fma_f32 v[110:111], v[110:111], v[38:39], v[38:39] op_sel:[0,1,1] op_sel_hi:[1,1,1]
    v_rcp_f32 v104, v104
    v_rcp_f32 v105, v105
    v_rcp_f32 v106, v106
    v_rcp_f32 v107, v107
    v_rcp_f32 v108, v108
    v_rcp_f32 v109, v109
    v_rcp_f32 v110, v110
    v_rcp_f32 v111, v111
    v_pk_mul_f32 v[104:105], v[104:105], v[120:121]
    v_pk_mul_f32 v[106:107], v[106:107], v[122:123]
    v_pk_mul_f32 v[108:109], v[108:109], v[124:125]
    v_pk_mul_f32 v[110:111], v[110:111], v[126:127]
    v_cvt_pk_bf16_f32 v60, v104, v105
    v_cvt_pk_bf16_f32 v61, v106, v107
    v_cvt_pk_bf16_f32 v62, v108, v109
    v_cvt_pk_bf16_f32 v63, v110, v111
    s_nop 0
    v_permlane16_swap_b32 v60, v62
    v_permlane16_swap_b32 v61, v63
    buffer_store_dwordx4 v[60:63], v6, s[4:7], s70 offen offset:1024 sc1
    v_pk_mul_f32 v[128:129], v[128:129], v[32:33] op_sel_hi:[1,0]
    v_pk_mul_f32 v[130:131], v[130:131], v[32:33] op_sel_hi:[1,0]
    v_pk_mul_f32 v[132:133], v[132:133], v[34:35] op_sel_hi:[1,0]
    v_pk_mul_f32 v[134:135], v[134:135], v[34:35] op_sel_hi:[1,0]
    v_exp_f32 v128, v128
    v_exp_f32 v129, v129
    v_exp_f32 v130, v130
    v_exp_f32 v131, v131
    v_exp_f32 v132, v132
    v_exp_f32 v133, v133
    v_exp_f32 v134, v134
    v_exp_f32 v135, v135
    v_pk_fma_f32 v[128:129], v[128:129], v[32:33], v[32:33] op_sel:[0,1,1] op_sel_hi:[1,1,1]
    v_pk_fma_f32 v[130:131], v[130:131], v[32:33], v[32:33] op_sel:[0,1,1] op_sel_hi:[1,1,1]
    v_pk_fma_f32 v[132:133], v[132:133], v[34:35], v[34:35] op_sel:[0,1,1] op_sel_hi:[1,1,1]
    v_pk_fma_f32 v[134:135], v[134:135], v[34:35], v[34:35] op_sel:[0,1,1] op_sel_hi:[1,1,1]
    v_rcp_f32 v128, v128
    v_rcp_f32 v129, v129
    v_rcp_f32 v130, v130
    v_rcp_f32 v131, v131
    v_rcp_f32 v132, v132
    v_rcp_f32 v133, v133
    v_rcp_f32 v134, v134
    v_rcp_f32 v135, v135
    v_pk_mul_f32 v[128:129], v[128:129], v[144:145]
    v_pk_mul_f32 v[130:131], v[130:131], v[146:147]
    v_pk_mul_f32 v[132:133], v[132:133], v[148:149]
    v_pk_mul_f32 v[134:135], v[134:135], v[150:151]
    v_cvt_pk_bf16_f32 v48, v128, v129
    v_cvt_pk_bf16_f32 v49, v130, v131
    v_cvt_pk_bf16_f32 v50, v132, v133
    v_cvt_pk_bf16_f32 v51, v134, v135
    s_nop 0
    v_permlane16_swap_b32 v48, v50
    v_permlane16_swap_b32 v49, v51
    buffer_store_dwordx4 v[48:51], v7, s[4:7], s70 offen offset:2048 sc1
    v_pk_mul_f32 v[136:137], v[136:137], v[36:37] op_sel_hi:[1,0]
    v_pk_mul_f32 v[138:139], v[138:139], v[36:37] op_sel_hi:[1,0]
    v_pk_mul_f32 v[140:141], v[140:141], v[38:39] op_sel_hi:[1,0]
    v_pk_mul_f32 v[142:143], v[142:143], v[38:39] op_sel_hi:[1,0]
    v_exp_f32 v136, v136
    v_exp_f32 v137, v137
    v_exp_f32 v138, v138
    v_exp_f32 v139, v139
    v_exp_f32 v140, v140
    v_exp_f32 v141, v141
    v_exp_f32 v142, v142
    v_exp_f32 v143, v143
    v_pk_fma_f32 v[136:137], v[136:137], v[36:37], v[36:37] op_sel:[0,1,1] op_sel_hi:[1,1,1]
    v_pk_fma_f32 v[138:139], v[138:139], v[36:37], v[36:37] op_sel:[0,1,1] op_sel_hi:[1,1,1]
    v_pk_fma_f32 v[140:141], v[140:141], v[38:39], v[38:39] op_sel:[0,1,1] op_sel_hi:[1,1,1]
    v_pk_fma_f32 v[142:143], v[142:143], v[38:39], v[38:39] op_sel:[0,1,1] op_sel_hi:[1,1,1]
    v_rcp_f32 v136, v136
    v_rcp_f32 v137, v137
    v_rcp_f32 v138, v138
    v_rcp_f32 v139, v139
    v_rcp_f32 v140, v140
    v_rcp_f32 v141, v141
    v_rcp_f32 v142, v142
    v_rcp_f32 v143, v143
    v_pk_mul_f32 v[136:137], v[136:137], v[152:153]
    v_pk_mul_f32 v[138:139], v[138:139], v[154:155]
    v_pk_mul_f32 v[140:141], v[140:141], v[156:157]
    v_pk_mul_f32 v[142:143], v[142:143], v[158:159]
    v_cvt_pk_bf16_f32 v52, v136, v137
    v_cvt_pk_bf16_f32 v53, v138, v139
    v_cvt_pk_bf16_f32 v54, v140, v141
    v_cvt_pk_bf16_f32 v55, v142, v143
    s_nop 0
    v_permlane16_swap_b32 v52, v54
    v_permlane16_swap_b32 v53, v55
    buffer_store_dwordx4 v[52:55], v6, s[4:7], s70 offen offset:2048 sc1
    v_pk_mul_f32 v[160:161], v[160:161], v[40:41] op_sel_hi:[1,0]
    v_pk_mul_f32 v[162:163], v[162:163], v[40:41] op_sel_hi:[1,0]
    v_pk_mul_f32 v[164:165], v[164:165], v[40:41] op_sel_hi:[1,0]
    v_pk_mul_f32 v[166:167], v[166:167], v[40:41] op_sel_hi:[1,0]
    v_exp_f32 v160, v160
    v_exp_f32 v161, v161
    v_exp_f32 v162, v162
    v_exp_f32 v163, v163
    v_exp_f32 v164, v164
    v_exp_f32 v165, v165
    v_exp_f32 v166, v166
    v_exp_f32 v167, v167
    v_pk_fma_f32 v[160:161], v[160:161], v[40:41], v[40:41] op_sel:[0,1,1] op_sel_hi:[1,1,1]
    v_pk_fma_f32 v[162:163], v[162:163], v[40:41], v[40:41] op_sel:[0,1,1] op_sel_hi:[1,1,1]
    v_pk_fma_f32 v[164:165], v[164:165], v[40:41], v[40:41] op_sel:[0,1,1] op_sel_hi:[1,1,1]
    v_pk_fma_f32 v[166:167], v[166:167], v[40:41], v[40:41] op_sel:[0,1,1] op_sel_hi:[1,1,1]
    v_rcp_f32 v160, v160
    v_rcp_f32 v161, v161
    v_rcp_f32 v162, v162
    v_rcp_f32 v163, v163
    v_rcp_f32 v164, v164
    v_rcp_f32 v165, v165
    v_rcp_f32 v166, v166
    v_rcp_f32 v167, v167
    v_pk_mul_f32 v[160:161], v[160:161], v[168:169]
    v_pk_mul_f32 v[162:163], v[162:163], v[170:171]
    v_pk_mul_f32 v[164:165], v[164:165], v[172:173]
    v_pk_mul_f32 v[166:167], v[166:167], v[174:175]
    v_cvt_pk_bf16_f32 v56, v160, v161
    v_cvt_pk_bf16_f32 v57, v162, v163
    v_cvt_pk_bf16_f32 v58, v164, v165
    v_cvt_pk_bf16_f32 v59, v166, v167
    buffer_store_dwordx4 v[56:59], v4, s[4:7], s71 offen sc1
    s_setprio 0
    s_lshl_b32 s29, s61, 4
    s_add_u32 s29, s29, s62
    s_lshl_b32 s29, s29, 6
    s_add_u32 s29, s29, 21102592
    s_lshl_b32 s23, s3, 14
    v_add_u32 v5, s23, v7
    v_and_b32 v3, 15, v2
    v_lshlrev_b32 v3, 6, v3
    s_waitcnt vmcnt(0)
    s_barrier
    s_cmp_lg_u32 s3, 0
    s_cbranch_scc1 L_nf3
    v_mov_b32 v48, s60
    v_mov_b32 v49, 0
    s_mov_b64 exec, 1
    buffer_store_dword v48, v49, s[4:7], s29 offen sc1
    s_mov_b64 exec, -1
L_nf3:
    s_lshr_b32 s29, s63, 1
    s_lshl_b32 s29, s29, 10
    s_lshl_b32 s23, s65, 8
    s_add_u32 s29, s29, s23
    s_add_u32 s29, s29, 21102592
    v_and_b32 v3, 3, v2
    v_lshlrev_b32 v3, 6, v3
    s_add_u32 s23, s62, 1
    s_bitcmp1_b32 s23, 1
    s_cbranch_scc1 L_p3s
    s_sleep 12
L_p3s:
    s_sleep 8
    s_mov_b32 s31, 0
L_p3:
    buffer_load_dword v48, v3, s[4:7], s29 offen sc1
    s_add_u32 s31, s31, 1
    s_waitcnt vmcnt(0)
    v_cmp_ne_u32 vcc, s60, v48
    s_cmp_gt_u32 s31, 4000
    s_cbranch_scc1 L_p3x
    s_and_b32 s30, vcc_lo, 3
    s_cbranch_scc0 L_p3x
    s_sleep 2
    s_branch L_p3
L_p3x:
    buffer_load_dwordx4 v[8:11], v7, s[4:7], s68 offen offset:0 sc1
    buffer_load_dwordx4 v[12:15], v6, s[4:7], s68 offen offset:0 sc1
    buffer_load_dwordx4 v[16:19], v7, s[4:7], s68 offen offset:1024 sc1
    buffer_load_dwordx4 v[20:23], v6, s[4:7], s68 offen offset:1024 sc1
    buffer_load_dwordx4 v[24:27], v7, s[4:7], s68 offen offset:2048 sc1
    buffer_load_dwordx4 v[28:31], v6, s[4:7], s68 offen offset:2048 sc1
    buffer_load_dwordx4 v[32:35], v7, s[4:7], s68 offen offset:3072 sc1
    buffer_load_dwordx4 v[36:39], v6, s[4:7], s68 offen offset:3072 sc1
    s_add_u32 s68, s68, 4096
    buffer_load_dwordx4 v[40:43], v7, s[4:7], s68 offen offset:0 sc1
    buffer_load_dwordx4 v[44:47], v6, s[4:7], s68 offen offset:0 sc1
    buffer_load_dwordx4 v[112:115], v7, s[4:7], s68 offen offset:1024 sc1
    buffer_load_dwordx4 v[116:119], v6, s[4:7], s68 offen offset:1024 sc1
    buffer_load_dwordx4 v[120:123], v7, s[4:7], s68 offen offset:2048 sc1
    buffer_load_dwordx4 v[124:127], v6, s[4:7], s68 offen offset:2048 sc1
    buffer_load_dwordx4 v[128:131], v7, s[4:7], s68 offen offset:3072 sc1
    buffer_load_dwordx4 v[132:135], v6, s[4:7], s68 offen offset:3072 sc1
    s_add_u32 s68, s68, 4096
    buffer_load_dwordx4 v[136:139], v7, s[4:7], s68 offen offset:0 sc1
    buffer_load_dwordx4 v[140:143], v6, s[4:7], s68 offen offset:0 sc1
    buffer_load_dwordx4 v[144:147], v7, s[4:7], s68 offen offset:1024 sc1
    buffer_load_dwordx4 v[148:151], v6, s[4:7], s68 offen offset:1024 sc1
    s_waitcnt vmcnt(19)
    v_mfma_f32_32x32x16_bf16 v[48:63], v[176:179], v[8:11], 0
    v_mfma_f32_32x32x16_bf16 v[64:79], v[180:183], v[8:11], 0
    s_waitcnt vmcnt(18)
    v_mfma_f32_32x32x16_bf16 v[80:95], v[176:179], v[12:15], 0
    v_mfma_f32_32x32x16_bf16 v[96:111], v[180:183], v[12:15], 0
    s_waitcnt vmcnt(17)
    v_mfma_f32_32x32x16_bf16 v[48:63], v[184:187], v[16:19], v[48:63]
    v_mfma_f32_32x32x16_bf16 v[64:79], v[188:191], v[16:19], v[64:79]
    s_waitcnt vmcnt(16)
    v_mfma_f32_32x32x16_bf16 v[80:95], v[184:187], v[20:23], v[80:95]
    v_mfma_f32_32x32x16_bf16 v[96:111], v[188:191], v[20:23], v[96:111]
    s_waitcnt vmcnt(15)
    v_mfma_f32_32x32x16_bf16 v[48:63], v[192:195], v[24:27], v[48:63]
    v_mfma_f32_32x32x16_bf16 v[64:79], v[196:199], v[24:27], v[64:79]
    s_waitcnt vmcnt(14)
    v_mfma_f32_32x32x16_bf16 v[80:95], v[192:195], v[28:31], v[80:95]
    v_mfma_f32_32x32x16_bf16 v[96:111], v[196:199], v[28:31], v[96:111]
    s_waitcnt vmcnt(13)
    v_mfma_f32_32x32x16_bf16 v[48:63], v[200:203], v[32:35], v[48:63]
    v_mfma_f32_32x32x16_bf16 v[64:79], v[204:207], v[32:35], v[64:79]
    s_waitcnt vmcnt(12)
    v_mfma_f32_32x32x16_bf16 v[80:95], v[200:203], v[36:39], v[80:95]
    v_mfma_f32_32x32x16_bf16 v[96:111], v[204:207], v[36:39], v[96:111]
    s_waitcnt vmcnt(11)
    v_mfma_f32_32x32x16_bf16 v[48:63], v[208:211], v[40:43], v[48:63]
    v_mfma_f32_32x32x16_bf16 v[64:79], v[212:215], v[40:43], v[64:79]
    s_waitcnt vmcnt(10)
    v_mfma_f32_32x32x16_bf16 v[80:95], v[208:211], v[44:47], v[80:95]
    v_mfma_f32_32x32x16_bf16 v[96:111], v[212:215], v[44:47], v[96:111]
    s_waitcnt vmcnt(9)
    v_mfma_f32_32x32x16_bf16 v[48:63], v[216:219], v[112:115], v[48:63]
    v_mfma_f32_32x32x16_bf16 v[64:79], v[220:223], v[112:115], v[64:79]
    s_waitcnt vmcnt(8)
    v_mfma_f32_32x32x16_bf16 v[80:95], v[216:219], v[116:119], v[80:95]
    v_mfma_f32_32x32x16_bf16 v[96:111], v[220:223], v[116:119], v[96:111]
    s_waitcnt vmcnt(7)
    v_mfma_f32_32x32x16_bf16 v[48:63], v[224:227], v[120:123], v[48:63]
    v_mfma_f32_32x32x16_bf16 v[64:79], v[228:231], v[120:123], v[64:79]
    s_waitcnt vmcnt(6)
    v_mfma_f32_32x32x16_bf16 v[80:95], v[224:227], v[124:127], v[80:95]
    v_mfma_f32_32x32x16_bf16 v[96:111], v[228:231], v[124:127], v[96:111]
    s_waitcnt vmcnt(5)
    v_mfma_f32_32x32x16_bf16 v[48:63], v[232:235], v[128:131], v[48:63]
    v_mfma_f32_32x32x16_bf16 v[64:79], v[236:239], v[128:131], v[64:79]
    s_waitcnt vmcnt(4)
    v_mfma_f32_32x32x16_bf16 v[80:95], v[232:235], v[132:135], v[80:95]
    v_mfma_f32_32x32x16_bf16 v[96:111], v[236:239], v[132:135], v[96:111]
    s_waitcnt vmcnt(3)
    v_mfma_f32_32x32x16_bf16 v[48:63], v[240:243], v[136:139], v[48:63]
    v_mfma_f32_32x32x16_bf16 v[64:79], v[244:247], v[136:139], v[64:79]
    s_waitcnt vmcnt(2)
    v_mfma_f32_32x32x16_bf16 v[80:95], v[240:243], v[140:143], v[80:95]
    v_mfma_f32_32x32x16_bf16 v[96:111], v[244:247], v[140:143], v[96:111]
    s_waitcnt vmcnt(1)
    v_mfma_f32_32x32x16_bf16 v[48:63], v[248:251], v[144:147], v[48:63]
    v_mfma_f32_32x32x16_bf16 v[64:79], v[252:255], v[144:147], v[64:79]
    s_waitcnt vmcnt(0)
    v_mfma_f32_32x32x16_bf16 v[80:95], v[248:251], v[148:151], v[80:95]
    v_mfma_f32_32x32x16_bf16 v[96:111], v[252:255], v[148:151], v[96:111]
    s_nop 7
    ds_write_b128 v5, v[48:51] offset:0
    ds_write_b128 v5, v[52:55] offset:1024
    ds_write_b128 v5, v[56:59] offset:2048
    ds_write_b128 v5, v[60:63] offset:3072
    ds_write_b128 v5, v[64:67] offset:4096
    ds_write_b128 v5, v[68:71] offset:5120
    ds_write_b128 v5, v[72:75] offset:6144
    ds_write_b128 v5, v[76:79] offset:7168
    ds_write_b128 v5, v[80:83] offset:8192
    ds_write_b128 v5, v[84:87] offset:9216
    ds_write_b128 v5, v[88:91] offset:10240
    ds_write_b128 v5, v[92:95] offset:11264
    ds_write_b128 v5, v[96:99] offset:12288
    ds_write_b128 v5, v[100:103] offset:13312
    ds_write_b128 v5, v[104:107] offset:14336
    ds_write_b128 v5, v[108:111] offset:15360
    s_waitcnt lgkmcnt(0)
    s_barrier
    s_or_b32 s23, s2, s3
    s_cmp_lg_u32 s23, 0
    s_cbranch_scc1 L_mend
    s_mov_b32 s29, 0x1430000
    v_mov_b32 v48, s60
    v_mov_b32 v49, 0
    s_mov_b64 exec, 1
    buffer_store_dword v48, v49, s[4:7], s29 offen sc1
    s_mov_b64 exec, -1
L_mend:
    s_endpgm
L_help:
    v_lshrrev_b32 v12, 3, v2
    v_and_b32 v13, 7, v2
    v_lshlrev_b32 v14, 4, v13
    v_lshl_add_u32 v14, v12, 10, v14
    v_add_u32 v15, 7168, v14
    s_lshr_b32 s29, s2, 1
    s_and_b32 s30, s2, 1
    s_lshl_b32 s30, s30, 2
    s_add_u32 s30, s30, s65
    s_lshl_b32 s31, s29, 14
    s_lshl_b32 s52, s30, 7
    s_add_u32 s31, s31, s52
    s_lshl_b32 s52, s65, 11
    s_add_u32 s52, s52, 143360
    s_mov_b32 m0, s52
    s_mul_i32 s53, s30, 112
    s_add_u32 s53, s53, s29
    s_lshl_b32 s53, s53, 11
    s_add_u32 s53, s53, 16777216
    s_mov_b32 s10, 0x1c0000
    s_mov_b32 s11, 0x20000
    s_waitcnt lgkmcnt(0)
    s_mov_b32 s8, s16
    s_mov_b32 s9, s17
    s_mov_b32 s4, s20
    s_mov_b32 s5, s21
    s_cmp_ge_u32 s2, 224
    s_cbranch_scc1 L_h0
    buffer_load_dwordx4 v14, s[8:11], s31 offen lds
    buffer_load_dwordx4 v15, s[8:11], s31 offen offset:1024 lds
L_h0:
    global_load_ushort v8, v4, s[38:39]
    global_load_ushort v9, v4, s[40:41]
    global_load_ushort v10, v4, s[42:43]
    global_load_ushort v11, v4, s[44:45]
    buffer_load_dword v16, v5, s[4:7], s23 offen sc1
    s_load_dword s27, s[46:47], s22
    s_load_dword s28, s[48:49], s22
    s_getpc_b64 s[54:55]
L_pc:
    s_add_u32 s54, s54, L_begin-L_pc
    s_addc_u32 s55, s55, -1
    s_lshr_b32 s29, s2, 3
    s_lshl_b32 s29, s29, 2
    s_add_u32 s29, s29, s65
    s_lshl_b32 s29, s29, 9
    v_and_b32 v17, 7, v2
    v_lshl_add_u32 v17, v17, 6, s29
    v_min_u32 v17, L_stop-L_begin-4, v17
    global_load_dword v17, v17, s[54:55]
    v_mov_b32 v24, 0
    v_mov_b32 v25, 0
    v_mov_b32 v26, 0
    v_mov_b32 v27, 0
    s_mul_i32 s29, s3, 4640
    s_add_u32 s29, s29, 72320
    v_add_u32 v28, s29, v7
    s_mul_i32 s29, s65, 4224
    s_add_u32 s29, s29, 109440
    v_add_u32 v29, s29, v7
    s_mov_b64 exec, 0xffffff
    ds_write_b128 v28, v[24:27]
    s_mov_b64 exec, 0x7f
    ds_write_b128 v29, v[24:27]
    s_mov_b64 exec, -1
    s_mul_i32 s29, s66, 16896
    s_mul_i32 s31, s25, 33792
    s_add_u32 s29, s29, s31
    s_and_b32 s31, s3, 1
    s_lshl_b32 s31, s31, 8
    s_add_u32 s29, s29, s31
    v_lshlrev_b32 v30, 2, v2
    v_add_u32 v30, s29, v30
    s_mul_i32 s29, s25, 18560
    s_add_u32 s29, s29, 72704
    v_and_b32 v3, 255, v0
    v_lshlrev_b32 v69, 4, v3
    v_add_u32 v68, s29, v69
    s_lshl_b32 s29, s25, 12
    s_add_u32 s29, s29, 126336
    v_add_u32 v69, s29, v69
    v_lshlrev_b32 v70, 6, v3
    v_subrev_u32 v71, 64, v70
    s_lshl_b32 s23, s2, 14
    s_add_u32 s32, s20, s23
    s_addc_u32 s33, s21, 0
    s_mov_b32 s34, 16384
    s_mov_b32 s35, 0x20000
    s_and_b32 s61, s2, 1
    s_lshl_b32 s61, s61, 3
    s_bfe_u32 s23, s2, 0x30003
    s_add_u32 s61, s61, s23
    s_bfe_u32 s62, s2, 0x20001
    s_lshl_b32 s62, s62, 2
    s_lshr_b32 s23, s2, 6
    s_add_u32 s62, s62, s23
    s_and_b32 s63, s2, 7
    s_lshl_b32 s63, s63, 2
    s_bfe_u32 s23, s2, 0x20003
    s_add_u32 s63, s63, s23
    s_lshr_b32 s64, s2, 5
    s_mul_i32 s67, s64, 112
    s_mul_i32 s23, s65, 28
    s_mul_i32 s29, s25, 10
    s_add_u32 s23, s23, s29
    s_add_u32 s67, s67, s23
    s_lshl_b32 s67, s67, 11
    s_add_u32 s67, s67, 16777216
    s_mul_i32 s68, s63, 224
    s_add_u32 s68, s68, s23
    s_lshl_b32 s68, s68, 10
    s_add_u32 s68, s68, 8388608
    v_lshrrev_b32 v18, 5, v2
    v_bfe_u32 v19, v2, 2, 2
    v_lshl_add_u32 v18, v18, 3, v19
    v_lshlrev_b32 v18, 7, v18
    v_and_b32 v19, 1, v2
    v_lshl_add_u32 v18, v19, 5, v18
    v_bfe_u32 v19, v2, 4, 1
    v_lshl_add_u32 v18, v19, 4, v18
    v_bfe_u32 v19, v2, 1, 1
    v_lshl_add_u32 v18, v19, 3, v18
    v_add_u32 v18, s52, v18
    s_barrier
    s_cmp_ge_u32 s2, 224
    s_cbranch_scc1 L_h1
    s_waitcnt vmcnt(6)
    ds_read_b64_tr_b16 v[88:89], v18 offset:0
    ds_read_b64_tr_b16 v[90:91], v18 offset:512
    ds_read_b64_tr_b16 v[92:93], v18 offset:64
    ds_read_b64_tr_b16 v[94:95], v18 offset:576
    s_waitcnt lgkmcnt(0)
    buffer_store_dwordx4 v[88:91], v7, s[4:7], s53 offen sc1
    buffer_store_dwordx4 v[92:95], v7, s[4:7], s53 offen offset:1024 sc1
    s_waitcnt vmcnt(3)
    s_branch L_h2
L_h1:
    s_waitcnt vmcnt(1) lgkmcnt(0)
L_h2:
    v_readfirstlane_b32 s60, v16
    s_lshl_b32 s29, s66, 4
    s_lshr_b32 s27, s27, s29
    s_lshl_b32 s27, s27, 16
    s_lshr_b32 s28, s28, s26
    s_lshl_b32 s28, s28, 16
    v_mov_b32 v33, 0x3fb8aa3b
    v_mul_f32 v34, s27, v33
    v_exp_f32 v34, v34
    v_lshlrev_b32 v8, 16, v8
    v_lshlrev_b32 v9, 16, v9
    v_cvt_pk_bf16_f32 v34, v34, v34
    v_and_b32 v34, 0xffff0000, v34
    v_mul_f32 v8, v8, v33
    v_exp_f32 v8, v8
    v_mul_f32 v9, v9, v34
    v_cvt_pk_bf16_f32 v8, v8, v8
    v_and_b32 v8, 0xffff0000, v8
    v_mul_f32 v8, v8, v34
    v_mul_f32 v9, 0x3e22f983, v9
    v_mul_f32 v8, 0xbfb8aa3b, v8
    s_mul_i32 s60, s60, 1664525
    s_add_u32 s60, s60, 1013904223
    v_sub_f32 v9, 0, v9
    v_exp_f32 v46, v8
    v_fract_f32 v47, v9
    v_cos_f32 v36, v47
    v_sin_f32 v37, v47
    v_mul_f32 v36, v36, v46
    v_mul_f32 v37, v37, v46
    v_mul_f32 v46, 0x41000000, v8
    v_mul_f32 v47, 0x41000000, v9
    v_exp_f32 v46, v46
    v_fract_f32 v47, v47
    v_cos_f32 v38, v47
    v_sin_f32 v39, v47
    v_mul_f32 v38, v38, v46
    v_mul_f32 v39, v39, v46
    v_mul_f32 v46, 0x43800000, v8
    v_mul_f32 v47, 0x43800000, v9
    v_exp_f32 v46, v46
    v_fract_f32 v47, v47
    v_cos_f32 v40, v47
    v_sin_f32 v41, v47
    v_mul_f32 v40, v40, v46
    v_mul_f32 v41, v41, v46
    v_add_f32 v34, v34, v34
    v_lshlrev_b32 v10, 16, v10
    v_lshlrev_b32 v11, 16, v11
    v_mul_f32 v54, v10, v34
    v_mul_f32 v55, -v11, v34
    v_cvt_pk_bf16_f32 v56, v54, v55
    ds_write_b32 v30, v56 offset:0
    v_pk_mul_f32 v[46:47], v[36:37], v[36:37] op_sel_hi:[0,1]
    v_pk_fma_f32 v[42:43], v[36:37], v[36:37], v[46:47] op_sel:[1,1,0] op_sel_hi:[1,0,1] neg_lo:[0,1,0]
    v_pk_mul_f32 v[46:47], v[54:55], v[36:37] op_sel_hi:[0,1]
    v_pk_fma_f32 v[50:51], v[54:55], v[36:37], v[46:47] op_sel:[1,1,0] op_sel_hi:[1,0,1] neg_lo:[0,1,0]
    v_cvt_pk_bf16_f32 v57, v50, v51
    ds_write_b32 v30, v57 offset:528
    v_pk_mul_f32 v[46:47], v[50:51], v[36:37] op_sel_hi:[0,1]
    v_pk_fma_f32 v[52:53], v[50:51], v[36:37], v[46:47] op_sel:[1,1,0] op_sel_hi:[1,0,1] neg_lo:[0,1,0]
    v_cvt_pk_bf16_f32 v58, v52, v53
    ds_write_b32 v30, v58 offset:1056
    v_pk_mul_f32 v[46:47], v[52:53], v[36:37] op_sel_hi:[0,1]
    v_pk_fma_f32 v[50:51], v[52:53], v[36:37], v[46:47] op_sel:[1,1,0] op_sel_hi:[1,0,1] neg_lo:[0,1,0]
    v_cvt_pk_bf16_f32 v59, v50, v51
    ds_write_b32 v30, v59 offset:1584
    v_pk_mul_f32 v[46:47], v[50:51], v[36:37] op_sel_hi:[0,1]
    v_pk_fma_f32 v[52:53], v[50:51], v[36:37], v[46:47] op_sel:[1,1,0] op_sel_hi:[1,0,1] neg_lo:[0,1,0]
    v_cvt_pk_bf16_f32 v56, v52, v53
    ds_write_b32 v30, v56 offset:4224
    v_pk_mul_f32 v[46:47], v[52:53], v[36:37] op_sel_hi:[0,1]
    v_pk_fma_f32 v[50:51], v[52:53], v[36:37], v[46:47] op_sel:[1,1,0] op_sel_hi:[1,0,1] neg_lo:[0,1,0]
    v_cvt_pk_bf16_f32 v57, v50, v51
    ds_write_b32 v30, v57 offset:4752
    v_pk_mul_f32 v[46:47], v[50:51], v[36:37] op_sel_hi:[0,1]
    v_pk_fma_f32 v[52:53], v[50:51], v[36:37], v[46:47] op_sel:[1,1,0] op_sel_hi:[1,0,1] neg_lo:[0,1,0]
    v_cvt_pk_bf16_f32 v58, v52, v53
    ds_write_b32 v30, v58 offset:5280
    v_pk_mul_f32 v[46:47], v[52:53], v[36:37] op_sel_hi:[0,1]
    v_pk_fma_f32 v[50:51], v[52:53], v[36:37], v[46:47] op_sel:[1,1,0] op_sel_hi:[1,0,1] neg_lo:[0,1,0]
    v_cvt_pk_bf16_f32 v59, v50, v51
    ds_write_b32 v30, v59 offset:5808
    v_pk_mul_f32 v[46:47], v[42:43], v[42:43] op_sel_hi:[0,1]
    v_pk_fma_f32 v[44:45], v[42:43], v[42:43], v[46:47] op_sel:[1,1,0] op_sel_hi:[1,0,1] neg_lo:[0,1,0]
    v_pk_mul_f32 v[46:47], v[54:55], v[40:41] op_sel_hi:[0,1]
    v_pk_fma_f32 v[48:49], v[54:55], v[40:41], v[46:47] op_sel:[1,1,0] op_sel_hi:[1,0,1] neg_lo:[0,1,0]
    v_cvt_pk_bf16_f32 v56, v48, v49
    ds_write_b32 v30, v56 offset:2112
    ds_write_b32 v30, v56 offset:2640
    v_pk_mul_f32 v[46:47], v[48:49], v[42:43] op_sel_hi:[0,1]
    v_pk_fma_f32 v[50:51], v[48:49], v[42:43], v[46:47] op_sel:[1,1,0] op_sel_hi:[1,0,1] neg_lo:[0,1,0]
    v_cvt_pk_bf16_f32 v57, v50, v51
    ds_write_b32 v30, v57 offset:3168
    v_pk_mul_f32 v[46:47], v[50:51], v[42:43] op_sel_hi:[0,1]
    v_pk_fma_f32 v[52:53], v[50:51], v[42:43], v[46:47] op_sel:[1,1,0] op_sel_hi:[1,0,1] neg_lo:[0,1,0]
    v_cvt_pk_bf16_f32 v58, v52, v53
    ds_write_b32 v30, v58 offset:3696
    ds_write_b32 v30, v58 offset:6336
    ds_write_b32 v30, v58 offset:6864
    v_pk_mul_f32 v[46:47], v[52:53], v[42:43] op_sel_hi:[0,1]
    v_pk_fma_f32 v[50:51], v[52:53], v[42:43], v[46:47] op_sel:[1,1,0] op_sel_hi:[1,0,1] neg_lo:[0,1,0]
    v_cvt_pk_bf16_f32 v59, v50, v51
    ds_write_b32 v30, v59 offset:7392
    v_pk_mul_f32 v[46:47], v[50:51], v[42:43] op_sel_hi:[0,1]
    v_pk_fma_f32 v[52:53], v[50:51], v[42:43], v[46:47] op_sel:[1,1,0] op_sel_hi:[1,0,1] neg_lo:[0,1,0]
    v_cvt_pk_bf16_f32 v56, v52, v53
    ds_write_b32 v30, v56 offset:7920
    v_pk_mul_f32 v[46:47], v[48:49], v[40:41] op_sel_hi:[0,1]
    v_pk_fma_f32 v[54:55], v[48:49], v[40:41], v[46:47] op_sel:[1,1,0] op_sel_hi:[1,0,1] neg_lo:[0,1,0]
    v_cvt_pk_bf16_f32 v57, v54, v55
    ds_write_b32 v30, v57 offset:8448
    v_pk_mul_f32 v[46:47], v[54:55], v[44:45] op_sel_hi:[0,1]
    v_pk_fma_f32 v[50:51], v[54:55], v[44:45], v[46:47] op_sel:[1,1,0] op_sel_hi:[1,0,1] neg_lo:[0,1,0]
    v_cvt_pk_bf16_f32 v58, v50, v51
    ds_write_b32 v30, v58 offset:8976
    v_pk_mul_f32 v[46:47], v[50:51], v[44:45] op_sel_hi:[0,1]
    v_pk_fma_f32 v[52:53], v[50:51], v[44:45], v[46:47] op_sel:[1,1,0] op_sel_hi:[1,0,1] neg_lo:[0,1,0]
    v_cvt_pk_bf16_f32 v59, v52, v53
    ds_write_b32 v30, v59 offset:9504
    v_pk_mul_f32 v[46:47], v[54:55], v[40:41] op_sel_hi:[0,1]
    v_pk_fma_f32 v[48:49], v[54:55], v[40:41], v[46:47] op_sel:[1,1,0] op_sel_hi:[1,0,1] neg_lo:[0,1,0]
    v_cvt_pk_bf16_f32 v56, v48, v49
    ds_write_b32 v30, v56 offset:10560
    v_pk_mul_f32 v[46:47], v[48:49], v[44:45] op_sel_hi:[0,1]
    v_pk_fma_f32 v[50:51], v[48:49], v[44:45], v[46:47] op_sel:[1,1,0] op_sel_hi:[1,0,1] neg_lo:[0,1,0]
    v_cvt_pk_bf16_f32 v57, v50, v51
    ds_write_b32 v30, v57 offset:11088
    v_pk_mul_f32 v[46:47], v[50:51], v[44:45] op_sel_hi:[0,1]
    v_pk_fma_f32 v[52:53], v[50:51], v[44:45], v[46:47] op_sel:[1,1,0] op_sel_hi:[1,0,1] neg_lo:[0,1,0]
    v_cvt_pk_bf16_f32 v58, v52, v53
    ds_write_b32 v30, v58 offset:11616
    v_pk_mul_f32 v[46:47], v[48:49], v[40:41] op_sel_hi:[0,1]
    v_pk_fma_f32 v[54:55], v[48:49], v[40:41], v[46:47] op_sel:[1,1,0] op_sel_hi:[1,0,1] neg_lo:[0,1,0]
    v_cvt_pk_bf16_f32 v59, v54, v55
    ds_write_b32 v30, v59 offset:10032
    v_pk_mul_f32 v[46:47], v[54:55], v[38:39] op_sel_hi:[0,1]
    v_pk_fma_f32 v[50:51], v[54:55], v[38:39], v[46:47] op_sel:[1,1,0] op_sel_hi:[1,0,1] neg_lo:[0,1,0]
    v_cvt_pk_bf16_f32 v56, v50, v51
    ds_write_b32 v30, v56 offset:12672
    v_pk_mul_f32 v[46:47], v[54:55], v[40:41] op_sel_hi:[0,1]
    v_pk_fma_f32 v[48:49], v[54:55], v[40:41], v[46:47] op_sel:[1,1,0] op_sel_hi:[1,0,1] neg_lo:[0,1,0]
    v_cvt_pk_bf16_f32 v57, v48, v49
    ds_write_b32 v30, v57 offset:12144
    v_pk_mul_f32 v[46:47], v[48:49], v[38:39] op_sel_hi:[0,1]
    v_pk_fma_f32 v[50:51], v[48:49], v[38:39], v[46:47] op_sel:[1,1,0] op_sel_hi:[1,0,1] neg_lo:[0,1,0]
    v_cvt_pk_bf16_f32 v58, v50, v51
    ds_write_b32 v30, v58 offset:14784
    v_pk_mul_f32 v[46:47], v[48:49], v[40:41] op_sel_hi:[0,1]
    v_pk_fma_f32 v[54:55], v[48:49], v[40:41], v[46:47] op_sel:[1,1,0] op_sel_hi:[1,0,1] neg_lo:[0,1,0]
    v_cvt_pk_bf16_f32 v59, v54, v55
    ds_write_b32 v30, v59 offset:13200
    v_pk_mul_f32 v[46:47], v[54:55], v[38:39] op_sel_hi:[0,1]
    v_pk_fma_f32 v[50:51], v[54:55], v[38:39], v[46:47] op_sel:[1,1,0] op_sel_hi:[1,0,1] neg_lo:[0,1,0]
    v_cvt_pk_bf16_f32 v56, v50, v51
    ds_write_b32 v30, v56 offset:13728
    v_pk_mul_f32 v[46:47], v[54:55], v[40:41] op_sel_hi:[0,1]
    v_pk_fma_f32 v[48:49], v[54:55], v[40:41], v[46:47] op_sel:[1,1,0] op_sel_hi:[1,0,1] neg_lo:[0,1,0]
    v_cvt_pk_bf16_f32 v57, v48, v49
    ds_write_b32 v30, v57 offset:15312
    v_pk_mul_f32 v[46:47], v[48:49], v[38:39] op_sel_hi:[0,1]
    v_pk_fma_f32 v[50:51], v[48:49], v[38:39], v[46:47] op_sel:[1,1,0] op_sel_hi:[1,0,1] neg_lo:[0,1,0]
    v_cvt_pk_bf16_f32 v58, v50, v51
    ds_write_b32 v30, v58 offset:15840
    s_lshr_b32 s52, s2, 3
    s_min_u32 s53, s52, 27
    s_and_b32 s29, s2, 1
    s_mul_i32 s29, s29, 28
    s_add_u32 s29, s29, s53
    s_mul_i32 s30, s29, 4682
    s_lshr_b32 s30, s30, 16
    s_mul_i32 s31, s30, 14
    s_sub_u32 s29, s29, s31
    s_cmp_ge_u32 s29, 7
    s_cselect_b32 s8, s14, s12
    s_cselect_b32 s9, s15, s13
    s_cselect_b32 s31, 7, 0
    s_cselect_b32 s53, 7168, 0
    s_sub_u32 s29, s29, s31
    s_bfe_u32 s31, s2, 0x20001
    s_mul_i32 s31, s31, 7
    s_add_u32 s29, s29, s31
    s_lshl_b32 s30, s30, 2
    s_add_u32 s30, s30, s65
    s_mul_i32 s31, s30, 114688
    s_lshl_b32 s54, s29, 7
    s_add_u32 s31, s31, s54
    s_mul_i32 s30, s30, 14336
    s_lshl_b32 s29, s29, 8
    s_add_u32 s30, s30, s29
    s_add_u32 s53, s53, s30
    s_add_u32 s53, s53, 4194304
    v_mul_u32_u24 v12, 3584, v12
    v_lshl_add_u32 v12, v13, 4, v12
    v_lshrrev_b32 v14, 4, v2
    v_lshlrev_b32 v14, 3, v14
    v_lshl_add_u32 v13, v13, 5, v14
    s_lshl_b32 s29, s2, 6
    s_add_u32 s29, s29, 20971520
    s_waitcnt vmcnt(0) lgkmcnt(0)
    s_barrier
    s_cmp_lg_u32 s3, 4
    s_cbranch_scc1 L_h3
    v_mov_b32 v20, s60
    v_mov_b32 v21, 0
    s_mov_b64 exec, 1
    buffer_store_dword v20, v21, s[4:7], s29 offen sc1
    s_mov_b64 exec, -1
L_h3:
    buffer_load_dwordx4 v[72:75], v12, s[8:11], s31 offen
    s_add_u32 s31, s31, 28672
    buffer_load_dwordx4 v[76:79], v12, s[8:11], s31 offen
    s_add_u32 s31, s31, 28672
    buffer_load_dwordx4 v[80:83], v12, s[8:11], s31 offen
    s_add_u32 s31, s31, 28672
    buffer_load_dwordx4 v[84:87], v12, s[8:11], s31 offen
    s_mov_b32 s75, s31
    s_bitcmp1_b32 s2, 0
    s_cbranch_scc1 L_nw
    s_mov_b32 s29, 0xcb000
    s_bitcmp1_b32 s2, 0
    s_cselect_b32 s29, 0xfff0b000, s29
    s_add_u32 s75, s75, s29
    buffer_load_dwordx4 v[88:91], v12, s[8:11], s75 offen
    s_add_u32 s75, s75, 28672
    buffer_load_dwordx4 v[88:91], v12, s[8:11], s75 offen
    s_add_u32 s75, s75, 28672
    buffer_load_dwordx4 v[88:91], v12, s[8:11], s75 offen
    s_add_u32 s75, s75, 28672
    buffer_load_dwordx4 v[88:91], v12, s[8:11], s75 offen
L_nw:
    v_lshrrev_b32 v3, 4, v2
    v_and_b32 v4, 15, v2
    v_lshlrev_b32 v5, 1, v3
    v_xor_b32 v4, v4, v5
    v_lshlrev_b32 v4, 4, v4
    v_lshl_add_u32 v4, v3, 12, v4
    s_lshl_b32 s29, s65, 15
    v_add_u32 v100, s29, v4
    v_xor_b32 v4, 128, v100
    v_add_u32 v101, 15360, v4
    s_lshl_b32 s70, s61, 8
    s_add_u32 s70, s70, 5242880
    s_mul_i32 s71, s62, 224
    s_mul_i32 s29, s66, 114688
    s_add_u32 s71, s71, s29
    s_lshl_b32 s72, s65, 11
    s_add_u32 s72, s72, 101248
    s_and_b32 s29, s65, 1
    s_mul_i32 s73, s29, 7184
    s_mul_i32 s30, s66, 14464
    s_add_u32 s73, s73, s30
    s_add_u32 s73, s73, 0
    s_cmp_eq_u32 s29, 0
    s_cselect_b32 s36, s12, s14
    s_cselect_b32 s37, s13, s15
    s_mov_b32 s38, 0x1c0000
    s_mov_b32 s39, 0x20000
    v_add_u32 v6, 0, v2
    v_mul_u32_u24 v5, 4682, v6
    v_lshrrev_b32 v5, 16, v5
    v_mul_u32_u24 v4, 14, v5
    v_sub_u32 v6, v6, v4
    v_mul_u32_u24 v5, 3584, v5
    v_lshl_add_u32 v102, v6, 4, v5
    v_add_u32 v6, 64, v2
    v_mul_u32_u24 v5, 4682, v6
    v_lshrrev_b32 v5, 16, v5
    v_mul_u32_u24 v4, 14, v5
    v_sub_u32 v6, v6, v4
    v_mul_u32_u24 v5, 3584, v5
    v_lshl_add_u32 v103, v6, 4, v5
    v_subrev_u32 v103, 1024, v103
    v_add_u32 v6, 128, v2
    v_mul_u32_u24 v5, 4682, v6
    v_lshrrev_b32 v5, 16, v5
    v_mul_u32_u24 v4, 14, v5
    v_sub_u32 v6, v6, v4
    v_mul_u32_u24 v5, 3584, v5
    v_lshl_add_u32 v104, v6, 4, v5
    v_subrev_u32 v104, 2048, v104
    v_add_u32 v6, 192, v2
    v_mul_u32_u24 v5, 4682, v6
    v_lshrrev_b32 v5, 16, v5
    v_mul_u32_u24 v4, 14, v5
    v_sub_u32 v6, v6, v4
    v_mul_u32_u24 v5, 3584, v5
    v_lshl_add_u32 v105, v6, 4, v5
    v_subrev_u32 v105, 3072, v105
    v_add_u32 v6, 256, v2
    v_mul_u32_u24 v5, 4682, v6
    v_lshrrev_b32 v5, 16, v5
    v_mul_u32_u24 v4, 14, v5
    v_sub_u32 v6, v6, v4
    v_mul_u32_u24 v5, 3584, v5
    v_lshl_add_u32 v106, v6, 4, v5
    v_add_u32 v6, 320, v2
    v_mul_u32_u24 v5, 4682, v6
    v_lshrrev_b32 v5, 16, v5
    v_mul_u32_u24 v4, 14, v5
    v_sub_u32 v6, v6, v4
    v_mul_u32_u24 v5, 3584, v5
    v_lshl_add_u32 v107, v6, 4, v5
    v_subrev_u32 v107, 1024, v107
    v_add_u32 v6, 384, v2
    v_mul_u32_u24 v5, 4682, v6
    v_lshrrev_b32 v5, 16, v5
    v_mul_u32_u24 v4, 14, v5
    v_sub_u32 v6, v6, v4
    v_mul_u32_u24 v5, 3584, v5
    v_lshl_add_u32 v108, v6, 4, v5
    v_subrev_u32 v108, 2048, v108
    s_barrier
    buffer_load_dwordx4 v[56:59], v71, s[32:35], s26 offen sc1
    buffer_load_dwordx4 v[60:63], v70, s[32:35], s26 offen sc1
    buffer_load_dwordx4 v[64:67], v70, s[32:35], s26 offen offset:32 sc1
    s_waitcnt vmcnt(1)
    v_mov_b32 v36, v57
    v_mov_b32 v37, v58
    v_mov_b32 v38, v59
    v_mov_b32 v39, v60
    v_mov_b32 v40, v61
    v_mov_b32 v41, v62
    ds_write_b128 v68, v[58:61] offset:4640
    ds_write_b128 v68, v[60:63] offset:13920
    ds_write_b128 v68, v[36:39]
    ds_write_b128 v68, v[38:41] offset:9280
    v_lshlrev_b32 v44, 16, v60
    v_and_b32 v45, 0xffff0000, v60
    v_lshlrev_b32 v46, 16, v61
    v_and_b32 v47, 0xffff0000, v61
    v_lshlrev_b32 v48, 16, v62
    v_and_b32 v49, 0xffff0000, v62
    v_lshlrev_b32 v50, 16, v63
    v_and_b32 v51, 0xffff0000, v63
    v_mul_f32 v44, s28, v44
    v_mul_f32 v45, s28, v45
    v_mul_f32 v46, s28, v46
    v_mul_f32 v47, s28, v47
    v_mul_f32 v48, s28, v48
    v_mul_f32 v49, s28, v49
    v_mul_f32 v50, s28, v50
    v_mul_f32 v51, s28, v51
    v_cvt_pk_bf16_f32 v52, v44, v45
    v_cvt_pk_bf16_f32 v53, v46, v47
    v_cvt_pk_bf16_f32 v54, v48, v49
    v_cvt_pk_bf16_f32 v55, v50, v51
    ds_write_b128 v69, v[52:55] offset:8192
    s_waitcnt vmcnt(0)
    ds_write_b128 v69, v[64:67]
    s_waitcnt lgkmcnt(0)
    s_barrier
    v_lshlrev_b32 v24, 16, v72
    v_and_b32 v25, 0xffff0000, v72
    v_lshlrev_b32 v26, 16, v73
    v_and_b32 v27, 0xffff0000, v73
    v_lshlrev_b32 v28, 16, v74
    v_and_b32 v29, 0xffff0000, v74
    v_lshlrev_b32 v30, 16, v75
    v_and_b32 v31, 0xffff0000, v75
    v_lshlrev_b32 v32, 16, v76
    v_and_b32 v33, 0xffff0000, v76
    v_add_f32 v24, v24, v32
    v_add_f32 v25, v25, v33
    v_lshlrev_b32 v32, 16, v77
    v_and_b32 v33, 0xffff0000, v77
    v_add_f32 v26, v26, v32
    v_add_f32 v27, v27, v33
    v_lshlrev_b32 v32, 16, v78
    v_and_b32 v33, 0xffff0000, v78
    v_add_f32 v28, v28, v32
    v_add_f32 v29, v29, v33
    v_lshlrev_b32 v32, 16, v79
    v_and_b32 v33, 0xffff0000, v79
    v_add_f32 v30, v30, v32
    v_add_f32 v31, v31, v33
    v_lshlrev_b32 v32, 16, v80
    v_and_b32 v33, 0xffff0000, v80
    v_add_f32 v24, v24, v32
    v_add_f32 v25, v25, v33
    v_lshlrev_b32 v32, 16, v81
    v_and_b32 v33, 0xffff0000, v81
    v_add_f32 v26, v26, v32
    v_add_f32 v27, v27, v33
    v_lshlrev_b32 v32, 16, v82
    v_and_b32 v33, 0xffff0000, v82
    v_add_f32 v28, v28, v32
    v_add_f32 v29, v29, v33
    v_lshlrev_b32 v32, 16, v83
    v_and_b32 v33, 0xffff0000, v83
    v_add_f32 v30, v30, v32
    v_add_f32 v31, v31, v33
    v_lshlrev_b32 v32, 16, v84
    v_and_b32 v33, 0xffff0000, v84
    v_add_f32 v24, v24, v32
    v_add_f32 v25, v25, v33
    v_lshlrev_b32 v32, 16, v85
    v_and_b32 v33, 0xffff0000, v85
    v_add_f32 v26, v26, v32
    v_add_f32 v27, v27, v33
    v_lshlrev_b32 v32, 16, v86
    v_and_b32 v33, 0xffff0000, v86
    v_add_f32 v28, v28, v32
    v_add_f32 v29, v29, v33
    v_lshlrev_b32 v32, 16, v87
    v_and_b32 v33, 0xffff0000, v87
    v_add_f32 v30, v30, v32
    v_add_f32 v31, v31, v33
    v_permlane32_swap_b32 v24, v28
    v_permlane32_swap_b32 v25, v29
    v_permlane32_swap_b32 v26, v30
    v_permlane32_swap_b32 v27, v31
    v_add_f32 v24, v24, v28
    v_add_f32 v25, v25, v29
    v_add_f32 v26, v26, v30
    v_add_f32 v27, v27, v31
    s_nop 0
    v_permlane16_swap_b32 v24, v26
    v_permlane16_swap_b32 v25, v27
    v_add_f32 v24, v24, v26
    v_add_f32 v25, v25, v27
    s_nop 0
    v_add_f32_dpp v24, v24, v24 row_ror:8 row_mask:0xf bank_mask:0xf
    v_add_f32_dpp v25, v25, v25 row_ror:8 row_mask:0xf bank_mask:0xf
    s_cmp_ge_u32 s52, 28
    s_cbranch_scc1 L_h4
    s_mov_b32 exec_lo, 0x00ff00ff
    s_mov_b32 exec_hi, 0x00ff00ff
    buffer_store_dwordx2 v[24:25], v13, s[4:7], s53 offen sc1
    s_mov_b64 exec, -1
L_h4:
    s_add_u32 m0, s73, 0
    s_add_u32 s31, s71, 0
    buffer_load_dwordx4 v102, s[36:39], s31 offen offset:0 lds
    buffer_load_dwordx4 v103, s[36:39], s31 offen offset:1024 lds
    buffer_load_dwordx4 v104, s[36:39], s31 offen offset:2048 lds
    buffer_load_dwordx4 v105, s[36:39], s31 offen offset:3072 lds
    s_add_u32 m0, s73, 4096
    s_nop 0
    buffer_load_dwordx4 v106, s[36:39], s31 offen offset:0 lds
    buffer_load_dwordx4 v107, s[36:39], s31 offen offset:1024 lds
    buffer_load_dwordx4 v108, s[36:39], s31 offen offset:2048 lds
    s_add_u32 m0, s73, 28928
    s_add_u32 s31, s71, 229376
    buffer_load_dwordx4 v102, s[36:39], s31 offen offset:0 lds
    buffer_load_dwordx4 v103, s[36:39], s31 offen offset:1024 lds
    buffer_load_dwordx4 v104, s[36:39], s31 offen offset:2048 lds
    buffer_load_dwordx4 v105, s[36:39], s31 offen offset:3072 lds
    s_add_u32 m0, s73, 33024
    s_nop 0
    buffer_load_dwordx4 v106, s[36:39], s31 offen offset:0 lds
    buffer_load_dwordx4 v107, s[36:39], s31 offen offset:1024 lds
    buffer_load_dwordx4 v108, s[36:39], s31 offen offset:2048 lds
    buffer_load_dwordx4 v[112:115], v7, s[4:7], s67 offen offset:0 sc1
    buffer_load_dwordx4 v[116:119], v7, s[4:7], s67 offen offset:1024 sc1
    buffer_load_dwordx4 v[120:123], v7, s[4:7], s67 offen offset:2048 sc1
    buffer_load_dwordx4 v[124:127], v7, s[4:7], s67 offen offset:3072 sc1
    s_add_u32 s67, s67, 4096
    buffer_load_dwordx4 v[128:131], v7, s[4:7], s67 offen offset:0 sc1
    buffer_load_dwordx4 v[132:135], v7, s[4:7], s67 offen offset:1024 sc1
    buffer_load_dwordx4 v[136:139], v7, s[4:7], s67 offen offset:2048 sc1
    buffer_load_dwordx4 v[140:143], v7, s[4:7], s67 offen offset:3072 sc1
    s_add_u32 s67, s67, 4096
    buffer_load_dwordx4 v[144:147], v7, s[4:7], s67 offen offset:0 sc1
    buffer_load_dwordx4 v[148:151], v7, s[4:7], s67 offen offset:1024 sc1
    buffer_load_dwordx4 v[152:155], v7, s[4:7], s67 offen offset:2048 sc1
    buffer_load_dwordx4 v[156:159], v7, s[4:7], s67 offen offset:3072 sc1
    s_add_u32 s67, s67, 4096
    buffer_load_dwordx4 v[160:163], v7, s[4:7], s67 offen offset:0 sc1
    buffer_load_dwordx4 v[164:167], v7, s[4:7], s67 offen offset:1024 sc1
    buffer_load_dwordx4 v[168:171], v7, s[4:7], s67 offen offset:2048 sc1
    buffer_load_dwordx4 v[172:175], v7, s[4:7], s67 offen offset:3072 sc1
    s_add_u32 s67, s67, 4096
    buffer_load_dwordx4 v[176:179], v7, s[4:7], s67 offen offset:0 sc1
    buffer_load_dwordx4 v[180:183], v7, s[4:7], s67 offen offset:1024 sc1
    buffer_load_dwordx4 v[184:187], v7, s[4:7], s67 offen offset:2048 sc1
    buffer_load_dwordx4 v[188:191], v7, s[4:7], s67 offen offset:3072 sc1
    s_add_u32 s67, s67, 4096
    buffer_load_dwordx4 v[192:195], v7, s[4:7], s67 offen offset:0 sc1
    buffer_load_dwordx4 v[196:199], v7, s[4:7], s67 offen offset:1024 sc1
    buffer_load_dwordx4 v[200:203], v7, s[4:7], s67 offen offset:2048 sc1
    buffer_load_dwordx4 v[204:207], v7, s[4:7], s67 offen offset:3072 sc1
    s_add_u32 s67, s67, 4096
    buffer_load_dwordx4 v[208:211], v7, s[4:7], s67 offen offset:0 sc1
    buffer_load_dwordx4 v[212:215], v7, s[4:7], s67 offen offset:1024 sc1
    buffer_load_dwordx4 v[216:219], v7, s[4:7], s67 offen offset:2048 sc1
    buffer_load_dwordx4 v[220:223], v7, s[4:7], s67 offen offset:3072 sc1
    s_add_u32 s67, s67, 4096
    buffer_load_dwordx4 v[224:227], v7, s[4:7], s67 offen offset:0 sc1
    buffer_load_dwordx4 v[228:231], v7, s[4:7], s67 offen offset:1024 sc1
    buffer_load_dwordx4 v[232:235], v7, s[4:7], s67 offen offset:2048 sc1
    buffer_load_dwordx4 v[236:239], v7, s[4:7], s67 offen offset:3072 sc1
    s_add_u32 s67, s67, 4096
    buffer_load_dwordx4 v[240:243], v7, s[4:7], s67 offen offset:0 sc1
    buffer_load_dwordx4 v[244:247], v7, s[4:7], s67 offen offset:1024 sc1
    buffer_load_dwordx4 v[248:251], v7, s[4:7], s67 offen offset:2048 sc1
    buffer_load_dwordx4 v[252:255], v7, s[4:7], s67 offen offset:3072 sc1
    v_and_b32 v3, 255, v0
    v_lshrrev_b32 v4, 5, v3
    v_lshlrev_b32 v4, 4, v4
    v_and_b32 v5, 15, v3
    v_add_u32 v4, v4, v5
    v_bfe_u32 v5, v3, 4, 1
    v_mul_u32_u24 v5, 112, v5
    v_add_u32 v4, v4, v5
    v_min_u32 v4, 223, v4
    v_lshlrev_b32 v4, 2, v4
    v_add_u32 v110, 150400, v4
    s_lshl_b32 s29, s65, 10
    s_add_u32 s29, s29, 150400
    v_add_u32 v111, s29, v7
    v_cmp_le_u32 vcc, 28, v2
    v_mov_b32 v5, 6720
    s_nop 0
    v_cndmask_b32 v4, 0, v5, vcc
    v_add_u32 v4, v4, v7
    v_cmp_gt_u32 vcc, 56, v2
    v_mov_b32 v5, 0x7fffff00
    s_nop 0
    v_cndmask_b32 v4, v5, v4, vcc
    s_mul_i32 s53, s62, 448
    s_mul_i32 s29, s65, 57344
    s_add_u32 s53, s53, s29
    s_add_u32 s53, s53, 4194304
    v_lshlrev_b32 v3, 4, v3
    v_add_u32 v3, 156544, v3
    v_lshrrev_b32 v5, 4, v2
    v_and_b32 v15, 15, v2
    v_lshlrev_b32 v12, 6, v15
    v_lshlrev_b32 v13, 4, v15
    v_lshl_add_u32 v6, v5, 12, v13
    s_lshl_b32 s29, s65, 8
    s_add_u32 s29, s29, 150400
    v_add_u32 v13, s29, v13
    v_lshlrev_b32 v15, 5, v15
    v_and_b32 v1, 1, v5
    v_lshl_add_u32 v15, v1, 4, v15
    v_lshrrev_b32 v1, 1, v5
    v_lshl_add_u32 v15, v1, 9, v15
    s_lshl_b32 s29, s65, 10
    s_add_u32 s29, s29, 150400
    v_add_u32 v15, s29, v15
    v_and_b32 v1, 7, v2
    v_lshlrev_b32 v14, 4, v1
    v_lshl_add_u32 v14, v5, 10, v14
    v_bfe_u32 v8, v2, 3, 1
    v_lshl_add_u32 v14, v8, 9, v14
    v_lshl_add_u32 v1, v1, 2, v5
    v_lshlrev_b32 v1, 4, v1
    s_lshl_b32 s29, s65, 9
    s_add_u32 s29, s29, 154496
    v_add_u32 v1, s29, v1
    s_lshl_b32 s54, s62, 17
    s_lshl_b32 s29, s65, 15
    s_add_u32 s54, s54, s29
    s_add_u32 s54, s54, s70
    s_lshl_b32 s29, s61, 4
    s_add_u32 s29, s29, s62
    s_lshl_b32 s56, s29, 6
    s_add_u32 s56, s56, 21233664
    s_lshl_b32 s55, s29, 10
    s_lshl_b32 s29, s65, 8
    s_add_u32 s55, s55, s29
    s_add_u32 s55, s55, 21299200
    s_lshl_b32 s57, s61, 10
    s_add_u32 s57, s57, 21233664
    s_lshl_b32 s58, s61, 14
    s_lshl_b32 s29, s65, 7
    s_add_u32 s58, s58, s29
    s_add_u32 s58, s58, 21299200
    v_lshlrev_b32 v5, 6, v2
    s_mov_b32 s29, 0x1410000
    s_waitcnt vmcnt(50)
    s_barrier
    s_add_u32 m0, s73, 57856
    s_add_u32 s31, s71, 458752
    buffer_load_dwordx4 v102, s[36:39], s31 offen offset:0 lds
    buffer_load_dwordx4 v103, s[36:39], s31 offen offset:1024 lds
    buffer_load_dwordx4 v104, s[36:39], s31 offen offset:2048 lds
    buffer_load_dwordx4 v105, s[36:39], s31 offen offset:3072 lds
    s_add_u32 m0, s73, 61952
    s_nop 0
    buffer_load_dwordx4 v106, s[36:39], s31 offen offset:0 lds
    buffer_load_dwordx4 v107, s[36:39], s31 offen offset:1024 lds
    buffer_load_dwordx4 v108, s[36:39], s31 offen offset:2048 lds
    s_cmp_lg_u32 s66, 0
    s_cbranch_scc1 L_w6
    s_add_u32 m0, s73, 0x15300
    s_add_u32 s31, s71, 688128
    buffer_load_dwordx4 v102, s[36:39], s31 offen offset:0 lds
    buffer_load_dwordx4 v103, s[36:39], s31 offen offset:1024 lds
    buffer_load_dwordx4 v104, s[36:39], s31 offen offset:2048 lds
    buffer_load_dwordx4 v105, s[36:39], s31 offen offset:3072 lds
    s_add_u32 m0, s73, 0x16300
    s_nop 0
    buffer_load_dwordx4 v106, s[36:39], s31 offen offset:0 lds
    buffer_load_dwordx4 v107, s[36:39], s31 offen offset:1024 lds
    buffer_load_dwordx4 v108, s[36:39], s31 offen offset:2048 lds
L_w6:
    s_barrier
    s_add_u32 m0, s72, 0
    s_add_u32 s31, s70, 0
    buffer_load_dwordx4 v100, s[4:7], s31 offen sc1 lds
    buffer_load_dwordx4 v101, s[4:7], s31 offen offset:1024 sc1 lds
    s_add_u32 m0, s72, 8192
    s_add_u32 s31, s70, 131072
    buffer_load_dwordx4 v100, s[4:7], s31 offen sc1 lds
    buffer_load_dwordx4 v101, s[4:7], s31 offen offset:1024 sc1 lds
    s_add_u32 m0, s72, 16384
    s_add_u32 s31, s70, 262144
    buffer_load_dwordx4 v100, s[4:7], s31 offen sc1 lds
    buffer_load_dwordx4 v101, s[4:7], s31 offen offset:1024 sc1 lds
    s_cmp_lg_u32 s66, 0
    s_cbranch_scc1 L_par1
    s_waitcnt vmcnt(4)
    s_barrier
    s_add_u32 m0, s72, 24576
    s_add_u32 s31, s70, 393216
    buffer_load_dwordx4 v100, s[4:7], s31 offen sc1 lds
    buffer_load_dwordx4 v101, s[4:7], s31 offen offset:1024 sc1 lds
    s_add_u32 m0, s72, 32768
    s_add_u32 s31, s70, 524288
    buffer_load_dwordx4 v100, s[4:7], s31 offen sc1 lds
    buffer_load_dwordx4 v101, s[4:7], s31 offen offset:1024 sc1 lds
    buffer_load_dwordx4 v[40:43], v6, s[4:7], s54 offen sc1
    s_add_u32 s54, s54, 16384
    buffer_load_dwordx4 v[44:47], v6, s[4:7], s54 offen sc1
    s_waitcnt vmcnt(8)
    s_barrier
    s_add_u32 m0, s72, 40960
    s_add_u32 s31, s70, 655360
    buffer_load_dwordx4 v100, s[4:7], s31 offen sc1 lds
    buffer_load_dwordx4 v101, s[4:7], s31 offen offset:1024 sc1 lds
    s_add_u32 m0, s72, 0
    s_add_u32 s31, s70, 786432
    buffer_load_dwordx4 v100, s[4:7], s31 offen sc1 lds
    buffer_load_dwordx4 v101, s[4:7], s31 offen offset:1024 sc1 lds
    s_waitcnt vmcnt(10)
    s_barrier
    s_add_u32 m0, s72, 8192
    s_add_u32 s31, s70, 917504
    buffer_load_dwordx4 v100, s[4:7], s31 offen sc1 lds
    buffer_load_dwordx4 v101, s[4:7], s31 offen offset:1024 sc1 lds
    s_waitcnt vmcnt(7)
    v_lshlrev_b32 v24, 16, v40
    v_and_b32 v25, 0xffff0000, v40
    v_mul_f32 v32, v24, v24
    v_mul_f32 v33, v25, v25
    v_lshlrev_b32 v26, 16, v41
    v_and_b32 v27, 0xffff0000, v41
    v_mul_f32 v34, v26, v26
    v_mul_f32 v35, v27, v27
    v_lshlrev_b32 v28, 16, v42
    v_and_b32 v29, 0xffff0000, v42
    v_mul_f32 v36, v28, v28
    v_mul_f32 v37, v29, v29
    v_lshlrev_b32 v30, 16, v43
    v_and_b32 v31, 0xffff0000, v43
    v_mul_f32 v38, v30, v30
    v_mul_f32 v39, v31, v31
    s_waitcnt vmcnt(6)
    v_lshlrev_b32 v52, 16, v44
    v_and_b32 v53, 0xffff0000, v44
    v_add_f32 v24, v24, v52
    v_add_f32 v25, v25, v53
    v_fmac_f32 v32, v52, v52
    v_fmac_f32 v33, v53, v53
    v_lshlrev_b32 v54, 16, v45
    v_and_b32 v55, 0xffff0000, v45
    v_add_f32 v26, v26, v54
    v_add_f32 v27, v27, v55
    v_fmac_f32 v34, v54, v54
    v_fmac_f32 v35, v55, v55
    v_lshlrev_b32 v52, 16, v46
    v_and_b32 v53, 0xffff0000, v46
    v_add_f32 v28, v28, v52
    v_add_f32 v29, v29, v53
    v_fmac_f32 v36, v52, v52
    v_fmac_f32 v37, v53, v53
    v_lshlrev_b32 v54, 16, v47
    v_and_b32 v55, 0xffff0000, v47
    v_add_f32 v30, v30, v54
    v_add_f32 v31, v31, v55
    v_fmac_f32 v38, v54, v54
    v_fmac_f32 v39, v55, v55
    s_waitcnt vmcnt(10)
    s_barrier
    s_add_u32 m0, s73, 0x3880
    s_add_u32 s31, s71, 917504
    buffer_load_dwordx4 v102, s[36:39], s31 offen offset:0 lds
    buffer_load_dwordx4 v103, s[36:39], s31 offen offset:1024 lds
    buffer_load_dwordx4 v104, s[36:39], s31 offen offset:2048 lds
    buffer_load_dwordx4 v105, s[36:39], s31 offen offset:3072 lds
    s_add_u32 m0, s73, 0x4880
    s_nop 0
    buffer_load_dwordx4 v106, s[36:39], s31 offen offset:0 lds
    buffer_load_dwordx4 v107, s[36:39], s31 offen offset:1024 lds
    buffer_load_dwordx4 v108, s[36:39], s31 offen offset:2048 lds
    s_add_u32 m0, s72, 16384
    s_add_u32 s31, s70, 1048576
    buffer_load_dwordx4 v100, s[4:7], s31 offen sc1 lds
    buffer_load_dwordx4 v101, s[4:7], s31 offen offset:1024 sc1 lds
    v_permlane32_swap_b32 v24, v32
    v_permlane32_swap_b32 v25, v33
    v_permlane32_swap_b32 v26, v34
    v_permlane32_swap_b32 v27, v35
    v_permlane32_swap_b32 v28, v36
    v_permlane32_swap_b32 v29, v37
    v_permlane32_swap_b32 v30, v38
    v_permlane32_swap_b32 v31, v39
    v_add_f32 v24, v24, v32
    v_add_f32 v25, v25, v33
    v_add_f32 v26, v26, v34
    v_add_f32 v27, v27, v35
    v_add_f32 v28, v28, v36
    v_add_f32 v29, v29, v37
    v_add_f32 v30, v30, v38
    v_add_f32 v31, v31, v39
    v_permlane16_swap_b32 v24, v28
    v_permlane16_swap_b32 v25, v29
    v_permlane16_swap_b32 v26, v30
    v_permlane16_swap_b32 v27, v31
    v_add_f32 v24, v24, v28
    v_add_f32 v25, v25, v29
    v_add_f32 v26, v26, v30
    v_add_f32 v27, v27, v31
    ds_write_b128 v15, v[24:27]
    s_waitcnt lgkmcnt(0)
    s_waitcnt vmcnt(17)
    s_barrier
    s_add_u32 m0, s72, 24576
    s_add_u32 s31, s70, 1179648
    buffer_load_dwordx4 v100, s[4:7], s31 offen sc1 lds
    buffer_load_dwordx4 v101, s[4:7], s31 offen offset:1024 sc1 lds
    ds_read_b128 v[24:27], v13 offset:0
    ds_read_b128 v[28:31], v13 offset:1024
    ds_read_b128 v[32:35], v13 offset:2048
    ds_read_b128 v[36:39], v13 offset:3072
    s_waitcnt lgkmcnt(2)
    v_add_f32 v24, v24, v28
    v_add_f32 v25, v25, v29
    v_add_f32 v26, v26, v30
    v_add_f32 v27, v27, v31
    s_waitcnt lgkmcnt(0)
    v_add_f32 v32, v32, v36
    v_add_f32 v33, v33, v37
    v_add_f32 v34, v34, v38
    v_add_f32 v35, v35, v39
    v_add_f32 v40, v24, v32
    v_add_f32 v41, v25, v33
    v_add_f32 v42, v26, v34
    v_add_f32 v43, v27, v35
    s_mov_b64 exec, 0xffff
    buffer_store_dwordx4 v[40:43], v7, s[4:7], s55 offen sc1
    s_mov_b64 exec, -1
    s_waitcnt vmcnt(16)
    s_barrier
    s_add_u32 m0, s73, 0xa980
    s_add_u32 s31, s71, 1146880
    buffer_load_dwordx4 v102, s[36:39], s31 offen offset:0 lds
    buffer_load_dwordx4 v103, s[36:39], s31 offen offset:1024 lds
    buffer_load_dwordx4 v104, s[36:39], s31 offen offset:2048 lds
    buffer_load_dwordx4 v105, s[36:39], s31 offen offset:3072 lds
    s_add_u32 m0, s73, 0xb980
    s_nop 0
    buffer_load_dwordx4 v106, s[36:39], s31 offen offset:0 lds
    buffer_load_dwordx4 v107, s[36:39], s31 offen offset:1024 lds
    buffer_load_dwordx4 v108, s[36:39], s31 offen offset:2048 lds
    s_add_u32 m0, s72, 32768
    s_add_u32 s31, s70, 1310720
    buffer_load_dwordx4 v100, s[4:7], s31 offen sc1 lds
    buffer_load_dwordx4 v101, s[4:7], s31 offen offset:1024 sc1 lds
    s_waitcnt vmcnt(23)
    s_barrier
    s_add_u32 m0, s72, 40960
    s_add_u32 s31, s70, 1441792
    buffer_load_dwordx4 v100, s[4:7], s31 offen sc1 lds
    buffer_load_dwordx4 v101, s[4:7], s31 offen offset:1024 sc1 lds
    s_waitcnt vmcnt(11)
    s_barrier
    v_mov_b32 v48, s60
    v_mov_b32 v49, 0
    s_mov_b64 exec, 1
    buffer_store_dword v48, v49, s[4:7], s56 offen sc1
    s_mov_b64 exec, -1
    s_add_u32 m0, s73, 0x11a80
    s_add_u32 s31, s71, 1376256
    buffer_load_dwordx4 v102, s[36:39], s31 offen offset:0 lds
    buffer_load_dwordx4 v103, s[36:39], s31 offen offset:1024 lds
    buffer_load_dwordx4 v104, s[36:39], s31 offen offset:2048 lds
    buffer_load_dwordx4 v105, s[36:39], s31 offen offset:3072 lds
    s_add_u32 m0, s73, 0x12a80
    s_nop 0
    buffer_load_dwordx4 v106, s[36:39], s31 offen offset:0 lds
    buffer_load_dwordx4 v107, s[36:39], s31 offen offset:1024 lds
    buffer_load_dwordx4 v108, s[36:39], s31 offen offset:2048 lds
    s_add_u32 m0, s72, 0
    s_add_u32 s31, s70, 1572864
    buffer_load_dwordx4 v100, s[4:7], s31 offen sc1 lds
    buffer_load_dwordx4 v101, s[4:7], s31 offen offset:1024 sc1 lds
    s_waitcnt vmcnt(21)
    s_barrier
    s_add_u32 m0, s72, 8192
    s_add_u32 s31, s70, 1703936
    buffer_load_dwordx4 v100, s[4:7], s31 offen sc1 lds
    buffer_load_dwordx4 v101, s[4:7], s31 offen offset:1024 sc1 lds
    buffer_load_dwordx4 v[72:75], v4, s[4:7], s53 offen sc1
    s_add_u32 s53, s53, 14336
    buffer_load_dwordx4 v[76:79], v4, s[4:7], s53 offen sc1
    s_add_u32 s53, s53, 14336
    buffer_load_dwordx4 v[80:83], v4, s[4:7], s53 offen sc1
    s_add_u32 s53, s53, 14336
    buffer_load_dwordx4 v[84:87], v4, s[4:7], s53 offen sc1
    s_waitcnt vmcnt(27)
    s_barrier
    s_add_u32 m0, s73, 0x0
    s_add_u32 s31, s71, 1605632
    buffer_load_dwordx4 v102, s[36:39], s31 offen offset:0 lds
    buffer_load_dwordx4 v103, s[36:39], s31 offen offset:1024 lds
    buffer_load_dwordx4 v104, s[36:39], s31 offen offset:2048 lds
    buffer_load_dwordx4 v105, s[36:39], s31 offen offset:3072 lds
    s_add_u32 m0, s73, 0x1000
    s_nop 0
    buffer_load_dwordx4 v106, s[36:39], s31 offen offset:0 lds
    buffer_load_dwordx4 v107, s[36:39], s31 offen offset:1024 lds
    buffer_load_dwordx4 v108, s[36:39], s31 offen offset:2048 lds
    s_add_u32 m0, s72, 16384
    s_add_u32 s31, s70, 1835008
    buffer_load_dwordx4 v100, s[4:7], s31 offen sc1 lds
    buffer_load_dwordx4 v101, s[4:7], s31 offen offset:1024 sc1 lds
    s_waitcnt vmcnt(27)
    s_barrier
    buffer_load_dword v50, v12, s[4:7], s57 offen sc1
    s_add_u32 m0, s72, 24576
    s_add_u32 s31, s70, 1966080
    buffer_load_dwordx4 v100, s[4:7], s31 offen sc1 lds
    buffer_load_dwordx4 v101, s[4:7], s31 offen offset:1024 sc1 lds
    s_waitcnt vmcnt(28)
    s_barrier
    s_waitcnt vmcnt(2)
    s_barrier
    v_xor_b32 v48, s60, v50
    v_cmp_ne_u32 vcc, 0, v48
    s_cbranch_vccz L_p40x
    s_mov_b32 s31, 0
L_p40:
    buffer_load_dword v48, v12, s[4:7], s57 offen sc1
    s_add_u32 s31, s31, 1
    s_waitcnt vmcnt(0)
    v_xor_b32 v48, s60, v48
    v_cmp_ne_u32 vcc, 0, v48
    s_cmp_gt_u32 s31, 4000
    s_cbranch_scc1 L_p40x
    s_cbranch_vccz L_p40x
    s_sleep 2
    s_branch L_p40
L_p40x:
    buffer_load_dwordx4 v[24:27], v14, s[4:7], s58 offen sc1
    s_add_u32 s58, s58, 4096
    buffer_load_dwordx4 v[28:31], v14, s[4:7], s58 offen sc1
    s_add_u32 s58, s58, 4096
    buffer_load_dwordx4 v[32:35], v14, s[4:7], s58 offen sc1
    s_add_u32 s58, s58, 4096
    buffer_load_dwordx4 v[36:39], v14, s[4:7], s58 offen sc1
    v_add_f32 v72, v72, v80
    v_add_f32 v73, v73, v81
    v_add_f32 v74, v74, v82
    v_add_f32 v75, v75, v83
    v_add_f32 v76, v76, v84
    v_add_f32 v77, v77, v85
    v_add_f32 v78, v78, v86
    v_add_f32 v79, v79, v87
    v_add_f32 v72, v72, v76
    v_add_f32 v73, v73, v77
    v_add_f32 v74, v74, v78
    v_add_f32 v75, v75, v79
    ds_write_b128 v111, v[72:75]
    s_waitcnt lgkmcnt(0)
    s_waitcnt vmcnt(6)
    s_barrier
    ds_read_b32 v72, v110 offset:0
    ds_read_b32 v73, v110 offset:1024
    ds_read_b32 v74, v110 offset:2048
    ds_read_b32 v75, v110 offset:3072
    s_waitcnt lgkmcnt(0)
    v_add_f32 v72, v72, v73
    v_add_f32 v74, v74, v75
    v_add_f32 v72, v72, v74
    v_cvt_pk_bf16_f32 v9, v72, v72
    v_and_b32 v9, 0xffff0000, v9
    v_sub_f32 v8, v72, v9
    v_cvt_pk_bf16_f32 v10, v8, v8
    v_and_b32 v10, 0xffff0000, v10
    v_sub_f32 v8, v8, v10
    v_cvt_pk_bf16_f32 v16, v9, v10
    v_cvt_pk_bf16_f32 v17, v8, 0
    v_mov_b32 v18, 0
    v_mov_b32 v19, 0
    ds_write_b128 v3, v[16:19]
    s_waitcnt lgkmcnt(0)
    s_waitcnt vmcnt(0)
    s_barrier
    v_add_f32 v24, v24, v32
    v_add_f32 v25, v25, v33
    v_add_f32 v26, v26, v34
    v_add_f32 v27, v27, v35
    v_add_f32 v28, v28, v36
    v_add_f32 v29, v29, v37
    v_add_f32 v30, v30, v38
    v_add_f32 v31, v31, v39
    v_add_f32 v24, v24, v28
    v_add_f32 v25, v25, v29
    v_add_f32 v26, v26, v30
    v_add_f32 v27, v27, v31
    s_nop 0
    v_permlane32_swap_b32 v24, v26
    v_permlane32_swap_b32 v25, v27
    v_add_f32 v24, v24, v26
    v_add_f32 v25, v25, v27
    s_nop 1
    v_permlane16_swap_b32 v24, v25
    v_add_f32 v40, v24, v25
    s_nop 1
    v_mov_b32_dpp v41, v40 row_ror:8 row_mask:0xf bank_mask:0xf
    v_mul_f32 v40, 0x3b000000, v40
    v_mul_f32 v41, 0x3b000000, v41
    v_fma_f32 v41, -v40, v40, v41
    v_max_f32 v41, 0, v41
    v_cvt_pk_bf16_f32 v41, v41, v41
    v_and_b32 v41, 0xffff0000, v41
    v_add_f32 v41, 0x3727c5ac, v41
    v_cvt_pk_bf16_f32 v41, v41, v41
    v_and_b32 v41, 0xffff0000, v41
    v_sqrt_f32 v41, v41
    v_cvt_pk_bf16_f32 v44, -v40, -v40
    v_cvt_pk_bf16_f32 v41, v41, v41
    v_and_b32 v47, 0xffff0000, v41
    v_rcp_f32 v46, v47
    v_mov_b32 v45, v44
    v_mul_f32 v46, 0xbfb8aa3b, v46
    s_mov_b32 exec_lo, 0x00ff00ff
    s_mov_b32 exec_hi, 0x00ff00ff
    ds_write_b128 v1, v[44:47]
    s_mov_b64 exec, -1
    s_waitcnt lgkmcnt(0)
    s_waitcnt vmcnt(0)
    s_barrier
    s_branch L_parx
L_par1:
    s_waitcnt vmcnt(4)
    s_barrier
    s_add_u32 m0, s72, 24576
    s_add_u32 s31, s70, 393216
    buffer_load_dwordx4 v100, s[4:7], s31 offen sc1 lds
    buffer_load_dwordx4 v101, s[4:7], s31 offen offset:1024 sc1 lds
    s_add_u32 m0, s72, 32768
    s_add_u32 s31, s70, 524288
    buffer_load_dwordx4 v100, s[4:7], s31 offen sc1 lds
    buffer_load_dwordx4 v101, s[4:7], s31 offen offset:1024 sc1 lds
    buffer_load_dwordx4 v[40:43], v6, s[4:7], s54 offen sc1
    s_add_u32 s54, s54, 16384
    buffer_load_dwordx4 v[44:47], v6, s[4:7], s54 offen sc1
    s_waitcnt vmcnt(8)
    s_barrier
    s_add_u32 m0, s72, 40960
    s_add_u32 s31, s70, 655360
    buffer_load_dwordx4 v100, s[4:7], s31 offen sc1 lds
    buffer_load_dwordx4 v101, s[4:7], s31 offen offset:1024 sc1 lds
    s_add_u32 m0, s72, 0
    s_add_u32 s31, s70, 786432
    buffer_load_dwordx4 v100, s[4:7], s31 offen sc1 lds
    buffer_load_dwordx4 v101, s[4:7], s31 offen offset:1024 sc1 lds
    s_waitcnt vmcnt(10)
    s_barrier
    s_add_u32 m0, s73, 0xffffc780
    s_add_u32 s31, s71, 688128
    buffer_load_dwordx4 v102, s[36:39], s31 offen offset:0 lds
    buffer_load_dwordx4 v103, s[36:39], s31 offen offset:1024 lds
    buffer_load_dwordx4 v104, s[36:39], s31 offen offset:2048 lds
    buffer_load_dwordx4 v105, s[36:39], s31 offen offset:3072 lds
    s_add_u32 m0, s73, 0xffffd780
    s_nop 0
    buffer_load_dwordx4 v106, s[36:39], s31 offen offset:0 lds
    buffer_load_dwordx4 v107, s[36:39], s31 offen offset:1024 lds
    buffer_load_dwordx4 v108, s[36:39], s31 offen offset:2048 lds
    s_add_u32 m0, s72, 8192
    s_add_u32 s31, s70, 917504
    buffer_load_dwordx4 v100, s[4:7], s31 offen sc1 lds
    buffer_load_dwordx4 v101, s[4:7], s31 offen offset:1024 sc1 lds
    s_waitcnt vmcnt(14)
    v_lshlrev_b32 v24, 16, v40
    v_and_b32 v25, 0xffff0000, v40
    v_mul_f32 v32, v24, v24
    v_mul_f32 v33, v25, v25
    v_lshlrev_b32 v26, 16, v41
    v_and_b32 v27, 0xffff0000, v41
    v_mul_f32 v34, v26, v26
    v_mul_f32 v35, v27, v27
    v_lshlrev_b32 v28, 16, v42
    v_and_b32 v29, 0xffff0000, v42
    v_mul_f32 v36, v28, v28
    v_mul_f32 v37, v29, v29
    v_lshlrev_b32 v30, 16, v43
    v_and_b32 v31, 0xffff0000, v43
    v_mul_f32 v38, v30, v30
    v_mul_f32 v39, v31, v31
    s_waitcnt vmcnt(13)
    v_lshlrev_b32 v52, 16, v44
    v_and_b32 v53, 0xffff0000, v44
    v_add_f32 v24, v24, v52
    v_add_f32 v25, v25, v53
    v_fmac_f32 v32, v52, v52
    v_fmac_f32 v33, v53, v53
    v_lshlrev_b32 v54, 16, v45
    v_and_b32 v55, 0xffff0000, v45
    v_add_f32 v26, v26, v54
    v_add_f32 v27, v27, v55
    v_fmac_f32 v34, v54, v54
    v_fmac_f32 v35, v55, v55
    v_lshlrev_b32 v52, 16, v46
    v_and_b32 v53, 0xffff0000, v46
    v_add_f32 v28, v28, v52
    v_add_f32 v29, v29, v53
    v_fmac_f32 v36, v52, v52
    v_fmac_f32 v37, v53, v53
    v_lshlrev_b32 v54, 16, v47
    v_and_b32 v55, 0xffff0000, v47
    v_add_f32 v30, v30, v54
    v_add_f32 v31, v31, v55
    v_fmac_f32 v38, v54, v54
    v_fmac_f32 v39, v55, v55
    s_waitcnt vmcnt(17)
    s_barrier
    s_add_u32 m0, s72, 16384
    s_add_u32 s31, s70, 1048576
    buffer_load_dwordx4 v100, s[4:7], s31 offen sc1 lds
    buffer_load_dwordx4 v101, s[4:7], s31 offen offset:1024 sc1 lds
    v_permlane32_swap_b32 v24, v32
    v_permlane32_swap_b32 v25, v33
    v_permlane32_swap_b32 v26, v34
    v_permlane32_swap_b32 v27, v35
    v_permlane32_swap_b32 v28, v36
    v_permlane32_swap_b32 v29, v37
    v_permlane32_swap_b32 v30, v38
    v_permlane32_swap_b32 v31, v39
    v_add_f32 v24, v24, v32
    v_add_f32 v25, v25, v33
    v_add_f32 v26, v26, v34
    v_add_f32 v27, v27, v35
    v_add_f32 v28, v28, v36
    v_add_f32 v29, v29, v37
    v_add_f32 v30, v30, v38
    v_add_f32 v31, v31, v39
    v_permlane16_swap_b32 v24, v28
    v_permlane16_swap_b32 v25, v29
    v_permlane16_swap_b32 v26, v30
    v_permlane16_swap_b32 v27, v31
    v_add_f32 v24, v24, v28
    v_add_f32 v25, v25, v29
    v_add_f32 v26, v26, v30
    v_add_f32 v27, v27, v31
    ds_write_b128 v15, v[24:27]
    s_waitcnt lgkmcnt(0)
    s_waitcnt vmcnt(17)
    s_barrier
    s_add_u32 m0, s73, 0x3880
    s_add_u32 s31, s71, 917504
    buffer_load_dwordx4 v102, s[36:39], s31 offen offset:0 lds
    buffer_load_dwordx4 v103, s[36:39], s31 offen offset:1024 lds
    buffer_load_dwordx4 v104, s[36:39], s31 offen offset:2048 lds
    buffer_load_dwordx4 v105, s[36:39], s31 offen offset:3072 lds
    s_add_u32 m0, s73, 0x4880
    s_nop 0
    buffer_load_dwordx4 v106, s[36:39], s31 offen offset:0 lds
    buffer_load_dwordx4 v107, s[36:39], s31 offen offset:1024 lds
    buffer_load_dwordx4 v108, s[36:39], s31 offen offset:2048 lds
    s_add_u32 m0, s72, 24576
    s_add_u32 s31, s70, 1179648
    buffer_load_dwordx4 v100, s[4:7], s31 offen sc1 lds
    buffer_load_dwordx4 v101, s[4:7], s31 offen offset:1024 sc1 lds
    ds_read_b128 v[24:27], v13 offset:0
    ds_read_b128 v[28:31], v13 offset:1024
    ds_read_b128 v[32:35], v13 offset:2048
    ds_read_b128 v[36:39], v13 offset:3072
    s_waitcnt lgkmcnt(2)
    v_add_f32 v24, v24, v28
    v_add_f32 v25, v25, v29
    v_add_f32 v26, v26, v30
    v_add_f32 v27, v27, v31
    s_waitcnt lgkmcnt(0)
    v_add_f32 v32, v32, v36
    v_add_f32 v33, v33, v37
    v_add_f32 v34, v34, v38
    v_add_f32 v35, v35, v39
    v_add_f32 v40, v24, v32
    v_add_f32 v41, v25, v33
    v_add_f32 v42, v26, v34
    v_add_f32 v43, v27, v35
    s_mov_b64 exec, 0xffff
    buffer_store_dwordx4 v[40:43], v7, s[4:7], s55 offen sc1
    s_mov_b64 exec, -1
    s_waitcnt vmcnt(23)
    s_barrier
    s_add_u32 m0, s72, 32768
    s_add_u32 s31, s70, 1310720
    buffer_load_dwordx4 v100, s[4:7], s31 offen sc1 lds
    buffer_load_dwordx4 v101, s[4:7], s31 offen offset:1024 sc1 lds
    s_waitcnt vmcnt(23)
    s_barrier
    s_add_u32 m0, s73, 0xa980
    s_add_u32 s31, s71, 1146880
    buffer_load_dwordx4 v102, s[36:39], s31 offen offset:0 lds
    buffer_load_dwordx4 v103, s[36:39], s31 offen offset:1024 lds
    buffer_load_dwordx4 v104, s[36:39], s31 offen offset:2048 lds
    buffer_load_dwordx4 v105, s[36:39], s31 offen offset:3072 lds
    s_add_u32 m0, s73, 0xb980
    s_nop 0
    buffer_load_dwordx4 v106, s[36:39], s31 offen offset:0 lds
    buffer_load_dwordx4 v107, s[36:39], s31 offen offset:1024 lds
    buffer_load_dwordx4 v108, s[36:39], s31 offen offset:2048 lds
    s_add_u32 m0, s72, 40960
    s_add_u32 s31, s70, 1441792
    buffer_load_dwordx4 v100, s[4:7], s31 offen sc1 lds
    buffer_load_dwordx4 v101, s[4:7], s31 offen offset:1024 sc1 lds
    s_waitcnt vmcnt(11)
    s_barrier
    v_mov_b32 v48, s60
    v_mov_b32 v49, 0
    s_mov_b64 exec, 1
    buffer_store_dword v48, v49, s[4:7], s56 offen sc1
    s_mov_b64 exec, -1
    s_add_u32 m0, s72, 0
    s_add_u32 s31, s70, 1572864
    buffer_load_dwordx4 v100, s[4:7], s31 offen sc1 lds
    buffer_load_dwordx4 v101, s[4:7], s31 offen offset:1024 sc1 lds
    s_waitcnt vmcnt(14)
    s_barrier
    s_add_u32 m0, s73, 0x11a80
    s_add_u32 s31, s71, 1376256
    buffer_load_dwordx4 v102, s[36:39], s31 offen offset:0 lds
    buffer_load_dwordx4 v103, s[36:39], s31 offen offset:1024 lds
    buffer_load_dwordx4 v104, s[36:39], s31 offen offset:2048 lds
    buffer_load_dwordx4 v105, s[36:39], s31 offen offset:3072 lds
    s_add_u32 m0, s73, 0x12a80
    s_nop 0
    buffer_load_dwordx4 v106, s[36:39], s31 offen offset:0 lds
    buffer_load_dwordx4 v107, s[36:39], s31 offen offset:1024 lds
    buffer_load_dwordx4 v108, s[36:39], s31 offen offset:2048 lds
    s_add_u32 m0, s72, 8192
    s_add_u32 s31, s70, 1703936
    buffer_load_dwordx4 v100, s[4:7], s31 offen sc1 lds
    buffer_load_dwordx4 v101, s[4:7], s31 offen offset:1024 sc1 lds
    buffer_load_dwordx4 v[72:75], v4, s[4:7], s53 offen sc1
    s_add_u32 s53, s53, 14336
    buffer_load_dwordx4 v[76:79], v4, s[4:7], s53 offen sc1
    s_add_u32 s53, s53, 14336
    buffer_load_dwordx4 v[80:83], v4, s[4:7], s53 offen sc1
    s_add_u32 s53, s53, 14336
    buffer_load_dwordx4 v[84:87], v4, s[4:7], s53 offen sc1
    s_waitcnt vmcnt(27)
    s_barrier
    s_add_u32 m0, s72, 16384
    s_add_u32 s31, s70, 1835008
    buffer_load_dwordx4 v100, s[4:7], s31 offen sc1 lds
    buffer_load_dwordx4 v101, s[4:7], s31 offen offset:1024 sc1 lds
    s_waitcnt vmcnt(27)
    s_barrier
    buffer_load_dword v50, v12, s[4:7], s57 offen sc1
    s_add_u32 m0, s73, 0x0
    s_add_u32 s31, s71, 1605632
    buffer_load_dwordx4 v102, s[36:39], s31 offen offset:0 lds
    buffer_load_dwordx4 v103, s[36:39], s31 offen offset:1024 lds
    buffer_load_dwordx4 v104, s[36:39], s31 offen offset:2048 lds
    buffer_load_dwordx4 v105, s[36:39], s31 offen offset:3072 lds
    s_add_u32 m0, s73, 0x1000
    s_nop 0
    buffer_load_dwordx4 v106, s[36:39], s31 offen offset:0 lds
    buffer_load_dwordx4 v107, s[36:39], s31 offen offset:1024 lds
    buffer_load_dwordx4 v108, s[36:39], s31 offen offset:2048 lds
    s_add_u32 m0, s72, 24576
    s_add_u32 s31, s70, 1966080
    buffer_load_dwordx4 v100, s[4:7], s31 offen sc1 lds
    buffer_load_dwordx4 v101, s[4:7], s31 offen offset:1024 sc1 lds
    s_waitcnt vmcnt(28)
    s_barrier
    s_waitcnt vmcnt(9)
    s_barrier
    v_xor_b32 v48, s60, v50
    v_cmp_ne_u32 vcc, 0, v48
    s_cbranch_vccz L_p41x
    s_mov_b32 s31, 0
L_p41:
    buffer_load_dword v48, v12, s[4:7], s57 offen sc1
    s_add_u32 s31, s31, 1
    s_waitcnt vmcnt(0)
    v_xor_b32 v48, s60, v48
    v_cmp_ne_u32 vcc, 0, v48
    s_cmp_gt_u32 s31, 4000
    s_cbranch_scc1 L_p41x
    s_cbranch_vccz L_p41x
    s_sleep 2
    s_branch L_p41
L_p41x:
    buffer_load_dwordx4 v[24:27], v14, s[4:7], s58 offen sc1
    s_add_u32 s58, s58, 4096
    buffer_load_dwordx4 v[28:31], v14, s[4:7], s58 offen sc1
    s_add_u32 s58, s58, 4096
    buffer_load_dwordx4 v[32:35], v14, s[4:7], s58 offen sc1
    s_add_u32 s58, s58, 4096
    buffer_load_dwordx4 v[36:39], v14, s[4:7], s58 offen sc1
    v_add_f32 v72, v72, v80
    v_add_f32 v73, v73, v81
    v_add_f32 v74, v74, v82
    v_add_f32 v75, v75, v83
    v_add_f32 v76, v76, v84
    v_add_f32 v77, v77, v85
    v_add_f32 v78, v78, v86
    v_add_f32 v79, v79, v87
    v_add_f32 v72, v72, v76
    v_add_f32 v73, v73, v77
    v_add_f32 v74, v74, v78
    v_add_f32 v75, v75, v79
    ds_write_b128 v111, v[72:75]
    s_waitcnt lgkmcnt(0)
    s_waitcnt vmcnt(13)
    s_barrier
    ds_read_b32 v72, v110 offset:0
    ds_read_b32 v73, v110 offset:1024
    ds_read_b32 v74, v110 offset:2048
    ds_read_b32 v75, v110 offset:3072
    s_waitcnt lgkmcnt(0)
    v_add_f32 v72, v72, v73
    v_add_f32 v74, v74, v75
    v_add_f32 v72, v72, v74
    v_cvt_pk_bf16_f32 v9, v72, v72
    v_and_b32 v9, 0xffff0000, v9
    v_sub_f32 v8, v72, v9
    v_cvt_pk_bf16_f32 v10, v8, v8
    v_and_b32 v10, 0xffff0000, v10
    v_sub_f32 v8, v8, v10
    v_cvt_pk_bf16_f32 v16, v9, v10
    v_cvt_pk_bf16_f32 v17, v8, 0
    v_mov_b32 v18, 0
    v_mov_b32 v19, 0
    ds_write_b128 v3, v[16:19]
    s_waitcnt lgkmcnt(0)
    s_waitcnt vmcnt(0)
    s_barrier
    v_add_f32 v24, v24, v32
    v_add_f32 v25, v25, v33
    v_add_f32 v26, v26, v34
    v_add_f32 v27, v27, v35
    v_add_f32 v28, v28, v36
    v_add_f32 v29, v29, v37
    v_add_f32 v30, v30, v38
    v_add_f32 v31, v31, v39
    v_add_f32 v24, v24, v28
    v_add_f32 v25, v25, v29
    v_add_f32 v26, v26, v30
    v_add_f32 v27, v27, v31
    s_nop 0
    v_permlane32_swap_b32 v24, v26
    v_permlane32_swap_b32 v25, v27
    v_add_f32 v24, v24, v26
    v_add_f32 v25, v25, v27
    s_nop 1
    v_permlane16_swap_b32 v24, v25
    v_add_f32 v40, v24, v25
    s_nop 1
    v_mov_b32_dpp v41, v40 row_ror:8 row_mask:0xf bank_mask:0xf
    v_mul_f32 v40, 0x3b000000, v40
    v_mul_f32 v41, 0x3b000000, v41
    v_fma_f32 v41, -v40, v40, v41
    v_max_f32 v41, 0, v41
    v_cvt_pk_bf16_f32 v41, v41, v41
    v_and_b32 v41, 0xffff0000, v41
    v_add_f32 v41, 0x3727c5ac, v41
    v_cvt_pk_bf16_f32 v41, v41, v41
    v_and_b32 v41, 0xffff0000, v41
    v_sqrt_f32 v41, v41
    v_cvt_pk_bf16_f32 v44, -v40, -v40
    v_cvt_pk_bf16_f32 v41, v41, v41
    v_and_b32 v47, 0xffff0000, v41
    v_rcp_f32 v46, v47
    v_mov_b32 v45, v44
    v_mul_f32 v46, 0xbfb8aa3b, v46
    s_mov_b32 exec_lo, 0x00ff00ff
    s_mov_b32 exec_hi, 0x00ff00ff
    ds_write_b128 v1, v[44:47]
    s_mov_b64 exec, -1
    s_waitcnt lgkmcnt(0)
    s_waitcnt vmcnt(0)
    s_barrier
L_parx:
    v_add_u32 v6, 114688, v7
    v_lshrrev_b32 v3, 2, v2
    v_lshlrev_b32 v3, 12, v3
    v_and_b32 v4, 3, v2
    v_lshl_add_u32 v3, v4, 4, v3
    v_add_u32 v4, 64512, v3
    s_and_b32 s29, s65, 1
    s_lshl_b32 s30, s64, 1
    s_add_u32 s29, s29, s30
    s_lshl_b32 s30, s63, 1
    s_add_u32 s30, s30, s66
    s_lshl_b32 s52, s29, 17
    s_lshl_b32 s53, s30, 6
    s_add_u32 s52, s52, s53
    s_add_u32 s52, s52, 5242880
    s_lshl_b32 s74, s30, 15
    s_lshl_b32 s53, s29, 6
    s_add_u32 s74, s74, s53
    s_lshl_b32 s53, s65, 11
    s_add_u32 s53, s53, 131072
    s_mov_b32 s8, s18
    s_mov_b32 s9, s19
    s_mov_b32 s10, 0x200000
    s_barrier
    s_mov_b32 m0, s53
    s_nop 0
    buffer_load_dwordx4 v3, s[4:7], s52 offen sc1 lds
    buffer_load_dwordx4 v4, s[4:7], s52 offen offset:1024 sc1 lds
    v_lshrrev_b32 v3, 5, v2
    v_bfe_u32 v4, v2, 2, 2
    v_lshl_add_u32 v4, v3, 4, v4
    v_lshlrev_b32 v4, 6, v4
    v_bfe_u32 v5, v2, 4, 1
    v_lshl_add_u32 v4, v5, 5, v4
    v_and_b32 v5, 3, v2
    v_lshl_add_u32 v4, v5, 3, v4
    v_add_u32 v4, s53, v4
    v_and_b32 v5, 31, v2
    v_lshlrev_b32 v5, 10, v5
    v_lshl_add_u32 v5, v3, 5, v5
    s_lshl_b32 s29, s65, 14
    s_add_u32 s29, s29, 65536
    v_add_u32 v3, s29, v7
    s_lshl_b32 s29, s65, 12
    v_add_u32 v1, s29, v7
    s_lshr_b32 s29, s63, 1
    s_lshl_b32 s29, s29, 10
    s_lshl_b32 s23, s65, 8
    s_add_u32 s29, s29, s23
    s_add_u32 s29, s29, 21102592
    v_and_b32 v0, 3, v2
    v_lshlrev_b32 v0, 6, v0
    s_add_u32 s23, s62, 1
    s_bitcmp1_b32 s23, 1
    s_cbranch_scc1 L_p3hs
    s_sleep 12
L_p3hs:
    s_sleep 8
    s_mov_b32 s31, 0
L_p3h:
    buffer_load_dword v2, v0, s[4:7], s29 offen sc1
    s_add_u32 s31, s31, 1
    s_waitcnt vmcnt(0)
    v_cmp_ne_u32 vcc, s60, v2
    s_cmp_gt_u32 s31, 4000
    s_cbranch_scc1 L_p3hx
    s_and_b32 s30, vcc_lo, 14
    s_cbranch_scc0 L_p3hx
    s_sleep 2
    s_branch L_p3h
L_p3hx:
    s_cmp_lt_u32 s65, 2
    s_cselect_b32 s23, 114688, 0
    s_cselect_b32 s29, 0, 114688
    s_cselect_b32 s30, 8192, 0
    s_cselect_b32 s31, 0, 8192
    v_add_u32 v6, s29, v7
    v_add_u32 v7, s23, v7
    v_add_u32 v0, s31, v3
    v_add_u32 v3, s30, v3
    buffer_load_dwordx4 v[8:11], v7, s[4:7], s68 offen offset:0 sc1
    buffer_load_dwordx4 v[12:15], v6, s[4:7], s68 offen offset:0 sc1
    buffer_load_dwordx4 v[16:19], v7, s[4:7], s68 offen offset:1024 sc1
    buffer_load_dwordx4 v[20:23], v6, s[4:7], s68 offen offset:1024 sc1
    buffer_load_dwordx4 v[24:27], v7, s[4:7], s68 offen offset:2048 sc1
    buffer_load_dwordx4 v[28:31], v6, s[4:7], s68 offen offset:2048 sc1
    buffer_load_dwordx4 v[32:35], v7, s[4:7], s68 offen offset:3072 sc1
    buffer_load_dwordx4 v[36:39], v6, s[4:7], s68 offen offset:3072 sc1
    s_add_u32 s68, s68, 4096
    buffer_load_dwordx4 v[40:43], v7, s[4:7], s68 offen offset:0 sc1
    buffer_load_dwordx4 v[44:47], v6, s[4:7], s68 offen offset:0 sc1
    s_add_u32 s29, s65, 1
    s_and_b32 s29, s29, 3
    s_lshl_b32 s29, s29, 14
    s_add_u32 s41, s29, 65536
    s_add_u32 s29, s65, 2
    s_and_b32 s29, s29, 3
    s_lshl_b32 s29, s29, 14
    s_add_u32 s42, s29, 65536
    s_add_u32 s29, s65, 3
    s_and_b32 s29, s29, 3
    s_lshl_b32 s29, s29, 14
    s_add_u32 s43, s29, 65536
    s_lshl_b32 s40, s65, 14
    s_waitcnt vmcnt(9)
    v_mfma_f32_32x32x16_bf16 v[48:63], v[112:115], v[8:11], 0
    v_mfma_f32_32x32x16_bf16 v[64:79], v[116:119], v[8:11], 0
    s_waitcnt vmcnt(8)
    v_mfma_f32_32x32x16_bf16 v[80:95], v[112:115], v[12:15], 0
    v_mfma_f32_32x32x16_bf16 v[96:111], v[116:119], v[12:15], 0
    buffer_load_dwordx4 v[8:11], v7, s[4:7], s68 offen offset:1024 sc1
    s_waitcnt vmcnt(8)
    v_mfma_f32_32x32x16_bf16 v[48:63], v[120:123], v[16:19], v[48:63]
    v_mfma_f32_32x32x16_bf16 v[64:79], v[124:127], v[16:19], v[64:79]
    buffer_load_dwordx4 v[12:15], v6, s[4:7], s68 offen offset:1024 sc1
    buffer_load_dwordx4 v[112:115], v7, s[4:7], s68 offen offset:2048 sc1
    s_waitcnt vmcnt(9)
    v_mfma_f32_32x32x16_bf16 v[80:95], v[120:123], v[20:23], v[80:95]
    v_mfma_f32_32x32x16_bf16 v[96:111], v[124:127], v[20:23], v[96:111]
    buffer_load_dwordx4 v[116:119], v6, s[4:7], s68 offen offset:2048 sc1
    buffer_load_dwordx4 v[16:19], v7, s[4:7], s68 offen offset:3072 sc1
    s_waitcnt vmcnt(10)
    v_mfma_f32_32x32x16_bf16 v[48:63], v[128:131], v[24:27], v[48:63]
    v_mfma_f32_32x32x16_bf16 v[64:79], v[132:135], v[24:27], v[64:79]
    buffer_load_dwordx4 v[20:23], v6, s[4:7], s68 offen offset:3072 sc1
    s_add_u32 s68, s68, 4096
    buffer_load_dwordx4 v[120:123], v7, s[4:7], s68 offen offset:0 sc1
    s_waitcnt vmcnt(11)
    v_mfma_f32_32x32x16_bf16 v[80:95], v[128:131], v[28:31], v[80:95]
    v_mfma_f32_32x32x16_bf16 v[96:111], v[132:135], v[28:31], v[96:111]
    buffer_load_dwordx4 v[124:127], v6, s[4:7], s68 offen offset:0 sc1
    buffer_load_dwordx4 v[24:27], v7, s[4:7], s68 offen offset:1024 sc1
    s_waitcnt vmcnt(12)
    v_mfma_f32_32x32x16_bf16 v[48:63], v[136:139], v[32:35], v[48:63]
    v_mfma_f32_32x32x16_bf16 v[64:79], v[140:143], v[32:35], v[64:79]
    buffer_load_dwordx4 v[28:31], v6, s[4:7], s68 offen offset:1024 sc1
    buffer_load_dwordx4 v[128:131], v7, s[4:7], s68 offen offset:2048 sc1
    s_waitcnt vmcnt(13)
    v_mfma_f32_32x32x16_bf16 v[80:95], v[136:139], v[36:39], v[80:95]
    v_mfma_f32_32x32x16_bf16 v[96:111], v[140:143], v[36:39], v[96:111]
    buffer_load_dwordx4 v[132:135], v6, s[4:7], s68 offen offset:2048 sc1
    buffer_load_dwordx4 v[32:35], v7, s[4:7], s68 offen offset:3072 sc1
    s_waitcnt vmcnt(14)
    v_mfma_f32_32x32x16_bf16 v[48:63], v[144:147], v[40:43], v[48:63]
    v_mfma_f32_32x32x16_bf16 v[64:79], v[148:151], v[40:43], v[64:79]
    buffer_load_dwordx4 v[36:39], v6, s[4:7], s68 offen offset:3072 sc1
    s_add_u32 s68, s68, 4096
    buffer_load_dwordx4 v[136:139], v7, s[4:7], s68 offen offset:0 sc1
    s_waitcnt vmcnt(15)
    v_mfma_f32_32x32x16_bf16 v[80:95], v[144:147], v[44:47], v[80:95]
    v_mfma_f32_32x32x16_bf16 v[96:111], v[148:151], v[44:47], v[96:111]
    buffer_load_dwordx4 v[140:143], v6, s[4:7], s68 offen offset:0 sc1
    buffer_load_dwordx4 v[40:43], v7, s[4:7], s68 offen offset:1024 sc1
    s_waitcnt vmcnt(16)
    v_mfma_f32_32x32x16_bf16 v[48:63], v[152:155], v[8:11], v[48:63]
    v_mfma_f32_32x32x16_bf16 v[64:79], v[156:159], v[8:11], v[64:79]
    buffer_load_dwordx4 v[44:47], v6, s[4:7], s68 offen offset:1024 sc1
    buffer_load_dwordx4 v[144:147], v7, s[4:7], s68 offen offset:2048 sc1
    s_waitcnt vmcnt(17)
    v_mfma_f32_32x32x16_bf16 v[80:95], v[152:155], v[12:15], v[80:95]
    v_mfma_f32_32x32x16_bf16 v[96:111], v[156:159], v[12:15], v[96:111]
    buffer_load_dwordx4 v[148:151], v7, s[4:7], s68 offen offset:3072 sc1
    s_add_u32 s68, s68, 4096
    buffer_load_dwordx4 v[8:11], v7, s[4:7], s68 offen offset:0 sc1
    s_waitcnt vmcnt(18)
    v_mfma_f32_32x32x16_bf16 v[48:63], v[160:163], v[112:115], v[48:63]
    v_mfma_f32_32x32x16_bf16 v[64:79], v[164:167], v[112:115], v[64:79]
    buffer_load_dwordx4 v[12:15], v7, s[4:7], s68 offen offset:1024 sc1
    s_sub_u32 s68, s68, 4096
    buffer_load_dwordx4 v[152:155], v6, s[4:7], s68 offen offset:2048 sc1
    s_waitcnt vmcnt(19)
    v_mfma_f32_32x32x16_bf16 v[80:95], v[160:163], v[116:119], v[80:95]
    v_mfma_f32_32x32x16_bf16 v[96:111], v[164:167], v[116:119], v[96:111]
    buffer_load_dwordx4 v[156:159], v6, s[4:7], s68 offen offset:3072 sc1
    s_add_u32 s68, s68, 4096
    buffer_load_dwordx4 v[112:115], v6, s[4:7], s68 offen offset:0 sc1
    s_waitcnt vmcnt(20)
    v_mfma_f32_32x32x16_bf16 v[48:63], v[168:171], v[16:19], v[48:63]
    v_mfma_f32_32x32x16_bf16 v[64:79], v[172:175], v[16:19], v[64:79]
    buffer_load_dwordx4 v[116:119], v6, s[4:7], s68 offen offset:1024 sc1
    s_waitcnt vmcnt(20)
    v_mfma_f32_32x32x16_bf16 v[80:95], v[168:171], v[20:23], v[80:95]
    v_mfma_f32_32x32x16_bf16 v[96:111], v[172:175], v[20:23], v[96:111]
    s_waitcnt vmcnt(19)
    v_mfma_f32_32x32x16_bf16 v[48:63], v[176:179], v[120:123], v[48:63]
    v_mfma_f32_32x32x16_bf16 v[64:79], v[180:183], v[120:123], v[64:79]
    s_waitcnt vmcnt(18)
    v_mfma_f32_32x32x16_bf16 v[80:95], v[176:179], v[124:127], v[80:95]
    v_mfma_f32_32x32x16_bf16 v[96:111], v[180:183], v[124:127], v[96:111]
    s_waitcnt vmcnt(17)
    v_mfma_f32_32x32x16_bf16 v[48:63], v[184:187], v[24:27], v[48:63]
    v_mfma_f32_32x32x16_bf16 v[64:79], v[188:191], v[24:27], v[64:79]
    s_waitcnt vmcnt(16)
    v_mfma_f32_32x32x16_bf16 v[80:95], v[184:187], v[28:31], v[80:95]
    v_mfma_f32_32x32x16_bf16 v[96:111], v[188:191], v[28:31], v[96:111]
    s_waitcnt vmcnt(15)
    v_mfma_f32_32x32x16_bf16 v[48:63], v[192:195], v[128:131], v[48:63]
    v_mfma_f32_32x32x16_bf16 v[64:79], v[196:199], v[128:131], v[64:79]
    s_waitcnt vmcnt(14)
    v_mfma_f32_32x32x16_bf16 v[80:95], v[192:195], v[132:135], v[80:95]
    v_mfma_f32_32x32x16_bf16 v[96:111], v[196:199], v[132:135], v[96:111]
    s_waitcnt vmcnt(13)
    v_mfma_f32_32x32x16_bf16 v[48:63], v[200:203], v[32:35], v[48:63]
    v_mfma_f32_32x32x16_bf16 v[64:79], v[204:207], v[32:35], v[64:79]
    s_waitcnt vmcnt(12)
    v_mfma_f32_32x32x16_bf16 v[80:95], v[200:203], v[36:39], v[80:95]
    v_mfma_f32_32x32x16_bf16 v[96:111], v[204:207], v[36:39], v[96:111]
    s_waitcnt vmcnt(11)
    v_mfma_f32_32x32x16_bf16 v[48:63], v[208:211], v[136:139], v[48:63]
    v_mfma_f32_32x32x16_bf16 v[64:79], v[212:215], v[136:139], v[64:79]
    s_waitcnt vmcnt(10)
    v_mfma_f32_32x32x16_bf16 v[80:95], v[208:211], v[140:143], v[80:95]
    v_mfma_f32_32x32x16_bf16 v[96:111], v[212:215], v[140:143], v[96:111]
    s_waitcnt vmcnt(9)
    v_mfma_f32_32x32x16_bf16 v[48:63], v[216:219], v[40:43], v[48:63]
    v_mfma_f32_32x32x16_bf16 v[64:79], v[220:223], v[40:43], v[64:79]
    s_waitcnt vmcnt(8)
    v_mfma_f32_32x32x16_bf16 v[80:95], v[216:219], v[44:47], v[80:95]
    v_mfma_f32_32x32x16_bf16 v[96:111], v[220:223], v[44:47], v[96:111]
    s_waitcnt vmcnt(7)
    v_mfma_f32_32x32x16_bf16 v[48:63], v[224:227], v[144:147], v[48:63]
    v_mfma_f32_32x32x16_bf16 v[64:79], v[228:231], v[144:147], v[64:79]
    s_waitcnt vmcnt(6)
    v_mfma_f32_32x32x16_bf16 v[48:63], v[232:235], v[148:151], v[48:63]
    v_mfma_f32_32x32x16_bf16 v[64:79], v[236:239], v[148:151], v[64:79]
    s_waitcnt vmcnt(5)
    v_mfma_f32_32x32x16_bf16 v[48:63], v[240:243], v[8:11], v[48:63]
    v_mfma_f32_32x32x16_bf16 v[64:79], v[244:247], v[8:11], v[64:79]
    s_waitcnt vmcnt(4)
    v_mfma_f32_32x32x16_bf16 v[48:63], v[248:251], v[12:15], v[48:63]
    v_mfma_f32_32x32x16_bf16 v[64:79], v[252:255], v[12:15], v[64:79]
    ds_read_b64_tr_b16 v[160:161], v4 offset:0
    ds_read_b64_tr_b16 v[162:163], v4 offset:256
    ds_read_b64_tr_b16 v[164:165], v4 offset:512
    ds_read_b64_tr_b16 v[166:167], v4 offset:768
    v_add_u32 v16, s40, v1
    v_add_u32 v17, s41, v1
    v_add_u32 v18, s42, v1
    v_add_u32 v19, s43, v1
    s_waitcnt vmcnt(3)
    v_mfma_f32_32x32x16_bf16 v[80:95], v[224:227], v[152:155], v[80:95]
    v_mfma_f32_32x32x16_bf16 v[96:111], v[228:231], v[152:155], v[96:111]
    s_waitcnt vmcnt(2)
    v_mfma_f32_32x32x16_bf16 v[80:95], v[232:235], v[156:159], v[80:95]
    ds_write_b128 v3, v[48:51] offset:0
    ds_write_b128 v3, v[52:55] offset:1024
    v_mfma_f32_32x32x16_bf16 v[96:111], v[236:239], v[156:159], v[96:111]
    ds_write_b128 v3, v[56:59] offset:2048
    ds_write_b128 v3, v[60:63] offset:3072
    s_waitcnt vmcnt(1)
    v_mfma_f32_32x32x16_bf16 v[80:95], v[240:243], v[112:115], v[80:95]
    ds_write_b128 v3, v[64:67] offset:4096
    ds_write_b128 v3, v[68:71] offset:5120
    v_mfma_f32_32x32x16_bf16 v[96:111], v[244:247], v[112:115], v[96:111]
    ds_write_b128 v3, v[72:75] offset:6144
    ds_write_b128 v3, v[76:79] offset:7168
    s_waitcnt vmcnt(0)
    s_bitcmp1_b32 s65, 0
    s_cbranch_scc1 L4_o1
    v_mfma_f32_32x32x16_bf16 v[96:111], v[252:255], v[116:119], v[96:111]
    v_mfma_f32_32x32x16_bf16 v[80:95], v[248:251], v[116:119], v[80:95]
    s_nop 10
    ds_write_b128 v0, v[96:99] offset:4096
    ds_write_b128 v0, v[100:103] offset:5120
    ds_write_b128 v0, v[104:107] offset:6144
    ds_write_b128 v0, v[108:111] offset:7168
    s_waitcnt lgkmcnt(0)
    s_barrier
    ds_read_b128 v[112:115], v1 offset:0
    ds_read_b128 v[116:119], v1 offset:1024
    ds_read_b128 v[120:123], v1 offset:2048
    ds_read_b128 v[124:127], v1 offset:3072
    ds_read_b128 v[128:131], v1 offset:16384
    ds_read_b128 v[132:135], v1 offset:17408
    ds_read_b128 v[136:139], v1 offset:18432
    ds_read_b128 v[140:143], v1 offset:19456
    ds_read_b128 v[144:147], v1 offset:32768
    ds_read_b128 v[148:151], v1 offset:33792
    ds_read_b128 v[152:155], v1 offset:34816
    ds_read_b128 v[156:159], v1 offset:35840
    v_and_b32 v25, 0xffff0000, v160
    v_lshlrev_b32 v24, 16, v160
    v_and_b32 v27, 0xffff0000, v161
    v_lshlrev_b32 v26, 16, v161
    v_and_b32 v29, 0xffff0000, v162
    v_lshlrev_b32 v28, 16, v162
    v_and_b32 v31, 0xffff0000, v163
    v_lshlrev_b32 v30, 16, v163
    v_and_b32 v33, 0xffff0000, v164
    v_lshlrev_b32 v32, 16, v164
    v_and_b32 v35, 0xffff0000, v165
    v_lshlrev_b32 v34, 16, v165
    v_and_b32 v37, 0xffff0000, v166
    v_lshlrev_b32 v36, 16, v166
    v_and_b32 v39, 0xffff0000, v167
    v_lshlrev_b32 v38, 16, v167
    s_waitcnt lgkmcnt(8)
    ds_read_b128 v[176:179], v1 offset:49152
    ds_read_b128 v[180:183], v1 offset:50176
    ds_read_b128 v[184:187], v1 offset:51200
    ds_read_b128 v[188:191], v1 offset:52224
    v_pk_add_f32 v[80:81], v[80:81], v[112:113]
    v_pk_add_f32 v[82:83], v[82:83], v[114:115]
    v_pk_add_f32 v[84:85], v[84:85], v[116:117]
    v_pk_add_f32 v[86:87], v[86:87], v[118:119]
    v_pk_add_f32 v[88:89], v[88:89], v[120:121]
    v_pk_add_f32 v[90:91], v[90:91], v[122:123]
    v_pk_add_f32 v[92:93], v[92:93], v[124:125]
    v_pk_add_f32 v[94:95], v[94:95], v[126:127]
    s_waitcnt lgkmcnt(8)
    ds_read_b128 v[192:195], v17 offset:0
    ds_read_b128 v[196:199], v17 offset:1024
    ds_read_b128 v[200:203], v17 offset:2048
    ds_read_b128 v[204:207], v17 offset:3072
    v_pk_add_f32 v[80:81], v[80:81], v[128:129]
    v_pk_add_f32 v[82:83], v[82:83], v[130:131]
    v_pk_add_f32 v[84:85], v[84:85], v[132:133]
    v_pk_add_f32 v[86:87], v[86:87], v[134:135]
    v_pk_add_f32 v[88:89], v[88:89], v[136:137]
    v_pk_add_f32 v[90:91], v[90:91], v[138:139]
    v_pk_add_f32 v[92:93], v[92:93], v[140:141]
    v_pk_add_f32 v[94:95], v[94:95], v[142:143]
    s_waitcnt lgkmcnt(8)
    ds_read_b128 v[208:211], v18 offset:0
    ds_read_b128 v[212:215], v18 offset:1024
    ds_read_b128 v[216:219], v18 offset:2048
    ds_read_b128 v[220:223], v18 offset:3072
    v_pk_add_f32 v[80:81], v[80:81], v[144:145]
    v_pk_add_f32 v[82:83], v[82:83], v[146:147]
    v_pk_add_f32 v[84:85], v[84:85], v[148:149]
    v_pk_add_f32 v[86:87], v[86:87], v[150:151]
    v_pk_add_f32 v[88:89], v[88:89], v[152:153]
    v_pk_add_f32 v[90:91], v[90:91], v[154:155]
    v_pk_add_f32 v[92:93], v[92:93], v[156:157]
    v_pk_add_f32 v[94:95], v[94:95], v[158:159]
    s_waitcnt lgkmcnt(8)
    ds_read_b128 v[224:227], v19 offset:0
    ds_read_b128 v[228:231], v19 offset:1024
    ds_read_b128 v[232:235], v19 offset:2048
    ds_read_b128 v[236:239], v19 offset:3072
    v_pk_add_f32 v[80:81], v[80:81], v[176:177]
    v_pk_add_f32 v[82:83], v[82:83], v[178:179]
    v_pk_add_f32 v[84:85], v[84:85], v[180:181]
    v_pk_add_f32 v[86:87], v[86:87], v[182:183]
    v_pk_add_f32 v[88:89], v[88:89], v[184:185]
    v_pk_add_f32 v[90:91], v[90:91], v[186:187]
    v_pk_add_f32 v[92:93], v[92:93], v[188:189]
    v_pk_add_f32 v[94:95], v[94:95], v[190:191]
    s_waitcnt lgkmcnt(8)
    v_pk_add_f32 v[80:81], v[80:81], v[192:193]
    v_pk_add_f32 v[82:83], v[82:83], v[194:195]
    v_pk_add_f32 v[84:85], v[84:85], v[196:197]
    v_pk_add_f32 v[86:87], v[86:87], v[198:199]
    v_pk_add_f32 v[88:89], v[88:89], v[200:201]
    v_pk_add_f32 v[90:91], v[90:91], v[202:203]
    v_pk_add_f32 v[92:93], v[92:93], v[204:205]
    v_pk_add_f32 v[94:95], v[94:95], v[206:207]
    s_waitcnt lgkmcnt(4)
    v_pk_add_f32 v[80:81], v[80:81], v[208:209]
    v_pk_add_f32 v[82:83], v[82:83], v[210:211]
    v_pk_add_f32 v[84:85], v[84:85], v[212:213]
    v_pk_add_f32 v[86:87], v[86:87], v[214:215]
    v_pk_add_f32 v[88:89], v[88:89], v[216:217]
    v_pk_add_f32 v[90:91], v[90:91], v[218:219]
    v_pk_add_f32 v[92:93], v[92:93], v[220:221]
    v_pk_add_f32 v[94:95], v[94:95], v[222:223]
    s_waitcnt lgkmcnt(0)
    v_pk_add_f32 v[80:81], v[80:81], v[224:225]
    v_pk_add_f32 v[82:83], v[82:83], v[226:227]
    v_pk_add_f32 v[84:85], v[84:85], v[228:229]
    v_pk_add_f32 v[86:87], v[86:87], v[230:231]
    v_pk_add_f32 v[88:89], v[88:89], v[232:233]
    v_pk_add_f32 v[90:91], v[90:91], v[234:235]
    v_pk_add_f32 v[92:93], v[92:93], v[236:237]
    v_pk_add_f32 v[94:95], v[94:95], v[238:239]
    v_cvt_pk_bf16_f32 v48, v80, v81
    v_cvt_pk_bf16_f32 v49, v82, v83
    v_cvt_pk_bf16_f32 v50, v84, v85
    v_cvt_pk_bf16_f32 v51, v86, v87
    v_lshlrev_b32 v80, 16, v48
    v_and_b32 v81, 0xffff0000, v48
    v_lshlrev_b32 v82, 16, v49
    v_and_b32 v83, 0xffff0000, v49
    v_lshlrev_b32 v84, 16, v50
    v_and_b32 v85, 0xffff0000, v50
    v_lshlrev_b32 v86, 16, v51
    v_and_b32 v87, 0xffff0000, v51
    v_pk_add_f32 v[80:81], v[80:81], v[24:25]
    v_pk_add_f32 v[82:83], v[82:83], v[26:27]
    v_pk_add_f32 v[84:85], v[84:85], v[28:29]
    v_pk_add_f32 v[86:87], v[86:87], v[30:31]
    v_cvt_pk_bf16_f32 v48, v80, v81
    v_cvt_pk_bf16_f32 v49, v82, v83
    v_cvt_pk_bf16_f32 v50, v84, v85
    v_cvt_pk_bf16_f32 v51, v86, v87
    buffer_store_dwordx4 v[48:51], v5, s[8:11], s74 offen offset:0
    v_cvt_pk_bf16_f32 v52, v88, v89
    v_cvt_pk_bf16_f32 v53, v90, v91
    v_cvt_pk_bf16_f32 v54, v92, v93
    v_cvt_pk_bf16_f32 v55, v94, v95
    v_lshlrev_b32 v88, 16, v52
    v_and_b32 v89, 0xffff0000, v52
    v_lshlrev_b32 v90, 16, v53
    v_and_b32 v91, 0xffff0000, v53
    v_lshlrev_b32 v92, 16, v54
    v_and_b32 v93, 0xffff0000, v54
    v_lshlrev_b32 v94, 16, v55
    v_and_b32 v95, 0xffff0000, v55
    v_pk_add_f32 v[88:89], v[88:89], v[32:33]
    v_pk_add_f32 v[90:91], v[90:91], v[34:35]
    v_pk_add_f32 v[92:93], v[92:93], v[36:37]
    v_pk_add_f32 v[94:95], v[94:95], v[38:39]
    v_cvt_pk_bf16_f32 v52, v88, v89
    v_cvt_pk_bf16_f32 v53, v90, v91
    v_cvt_pk_bf16_f32 v54, v92, v93
    v_cvt_pk_bf16_f32 v55, v94, v95
    buffer_store_dwordx4 v[52:55], v5, s[8:11], s74 offen offset:16
    s_branch L4_e
L4_o1:
    v_mfma_f32_32x32x16_bf16 v[80:95], v[248:251], v[116:119], v[80:95]
    v_mfma_f32_32x32x16_bf16 v[96:111], v[252:255], v[116:119], v[96:111]
    s_nop 10
    ds_write_b128 v0, v[80:83] offset:0
    ds_write_b128 v0, v[84:87] offset:1024
    ds_write_b128 v0, v[88:91] offset:2048
    ds_write_b128 v0, v[92:95] offset:3072
    s_waitcnt lgkmcnt(0)
    s_barrier
    ds_read_b128 v[112:115], v1 offset:0
    ds_read_b128 v[116:119], v1 offset:1024
    ds_read_b128 v[120:123], v1 offset:2048
    ds_read_b128 v[124:127], v1 offset:3072
    ds_read_b128 v[128:131], v1 offset:16384
    ds_read_b128 v[132:135], v1 offset:17408
    ds_read_b128 v[136:139], v1 offset:18432
    ds_read_b128 v[140:143], v1 offset:19456
    ds_read_b128 v[144:147], v1 offset:32768
    ds_read_b128 v[148:151], v1 offset:33792
    ds_read_b128 v[152:155], v1 offset:34816
    ds_read_b128 v[156:159], v1 offset:35840
    v_and_b32 v25, 0xffff0000, v160
    v_lshlrev_b32 v24, 16, v160
    v_and_b32 v27, 0xffff0000, v161
    v_lshlrev_b32 v26, 16, v161
    v_and_b32 v29, 0xffff0000, v162
    v_lshlrev_b32 v28, 16, v162
    v_and_b32 v31, 0xffff0000, v163
    v_lshlrev_b32 v30, 16, v163
    v_and_b32 v33, 0xffff0000, v164
    v_lshlrev_b32 v32, 16, v164
    v_and_b32 v35, 0xffff0000, v165
    v_lshlrev_b32 v34, 16, v165
    v_and_b32 v37, 0xffff0000, v166
    v_lshlrev_b32 v36, 16, v166
    v_and_b32 v39, 0xffff0000, v167
    v_lshlrev_b32 v38, 16, v167
    s_waitcnt lgkmcnt(8)
    ds_read_b128 v[176:179], v1 offset:49152
    ds_read_b128 v[180:183], v1 offset:50176
    ds_read_b128 v[184:187], v1 offset:51200
    ds_read_b128 v[188:191], v1 offset:52224
    v_pk_add_f32 v[96:97], v[96:97], v[112:113]
    v_pk_add_f32 v[98:99], v[98:99], v[114:115]
    v_pk_add_f32 v[100:101], v[100:101], v[116:117]
    v_pk_add_f32 v[102:103], v[102:103], v[118:119]
    v_pk_add_f32 v[104:105], v[104:105], v[120:121]
    v_pk_add_f32 v[106:107], v[106:107], v[122:123]
    v_pk_add_f32 v[108:109], v[108:109], v[124:125]
    v_pk_add_f32 v[110:111], v[110:111], v[126:127]
    s_waitcnt lgkmcnt(8)
    ds_read_b128 v[192:195], v17 offset:0
    ds_read_b128 v[196:199], v17 offset:1024
    ds_read_b128 v[200:203], v17 offset:2048
    ds_read_b128 v[204:207], v17 offset:3072
    v_pk_add_f32 v[96:97], v[96:97], v[128:129]
    v_pk_add_f32 v[98:99], v[98:99], v[130:131]
    v_pk_add_f32 v[100:101], v[100:101], v[132:133]
    v_pk_add_f32 v[102:103], v[102:103], v[134:135]
    v_pk_add_f32 v[104:105], v[104:105], v[136:137]
    v_pk_add_f32 v[106:107], v[106:107], v[138:139]
    v_pk_add_f32 v[108:109], v[108:109], v[140:141]
    v_pk_add_f32 v[110:111], v[110:111], v[142:143]
    s_waitcnt lgkmcnt(8)
    ds_read_b128 v[208:211], v18 offset:0
    ds_read_b128 v[212:215], v18 offset:1024
    ds_read_b128 v[216:219], v18 offset:2048
    ds_read_b128 v[220:223], v18 offset:3072
    v_pk_add_f32 v[96:97], v[96:97], v[144:145]
    v_pk_add_f32 v[98:99], v[98:99], v[146:147]
    v_pk_add_f32 v[100:101], v[100:101], v[148:149]
    v_pk_add_f32 v[102:103], v[102:103], v[150:151]
    v_pk_add_f32 v[104:105], v[104:105], v[152:153]
    v_pk_add_f32 v[106:107], v[106:107], v[154:155]
    v_pk_add_f32 v[108:109], v[108:109], v[156:157]
    v_pk_add_f32 v[110:111], v[110:111], v[158:159]
    s_waitcnt lgkmcnt(8)
    ds_read_b128 v[224:227], v19 offset:0
    ds_read_b128 v[228:231], v19 offset:1024
    ds_read_b128 v[232:235], v19 offset:2048
    ds_read_b128 v[236:239], v19 offset:3072
    v_pk_add_f32 v[96:97], v[96:97], v[176:177]
    v_pk_add_f32 v[98:99], v[98:99], v[178:179]
    v_pk_add_f32 v[100:101], v[100:101], v[180:181]
    v_pk_add_f32 v[102:103], v[102:103], v[182:183]
    v_pk_add_f32 v[104:105], v[104:105], v[184:185]
    v_pk_add_f32 v[106:107], v[106:107], v[186:187]
    v_pk_add_f32 v[108:109], v[108:109], v[188:189]
    v_pk_add_f32 v[110:111], v[110:111], v[190:191]
    s_waitcnt lgkmcnt(8)
    v_pk_add_f32 v[96:97], v[96:97], v[192:193]
    v_pk_add_f32 v[98:99], v[98:99], v[194:195]
    v_pk_add_f32 v[100:101], v[100:101], v[196:197]
    v_pk_add_f32 v[102:103], v[102:103], v[198:199]
    v_pk_add_f32 v[104:105], v[104:105], v[200:201]
    v_pk_add_f32 v[106:107], v[106:107], v[202:203]
    v_pk_add_f32 v[108:109], v[108:109], v[204:205]
    v_pk_add_f32 v[110:111], v[110:111], v[206:207]
    s_waitcnt lgkmcnt(4)
    v_pk_add_f32 v[96:97], v[96:97], v[208:209]
    v_pk_add_f32 v[98:99], v[98:99], v[210:211]
    v_pk_add_f32 v[100:101], v[100:101], v[212:213]
    v_pk_add_f32 v[102:103], v[102:103], v[214:215]
    v_pk_add_f32 v[104:105], v[104:105], v[216:217]
    v_pk_add_f32 v[106:107], v[106:107], v[218:219]
    v_pk_add_f32 v[108:109], v[108:109], v[220:221]
    v_pk_add_f32 v[110:111], v[110:111], v[222:223]
    s_waitcnt lgkmcnt(0)
    v_pk_add_f32 v[96:97], v[96:97], v[224:225]
    v_pk_add_f32 v[98:99], v[98:99], v[226:227]
    v_pk_add_f32 v[100:101], v[100:101], v[228:229]
    v_pk_add_f32 v[102:103], v[102:103], v[230:231]
    v_pk_add_f32 v[104:105], v[104:105], v[232:233]
    v_pk_add_f32 v[106:107], v[106:107], v[234:235]
    v_pk_add_f32 v[108:109], v[108:109], v[236:237]
    v_pk_add_f32 v[110:111], v[110:111], v[238:239]
    v_cvt_pk_bf16_f32 v48, v96, v97
    v_cvt_pk_bf16_f32 v49, v98, v99
    v_cvt_pk_bf16_f32 v50, v100, v101
    v_cvt_pk_bf16_f32 v51, v102, v103
    v_lshlrev_b32 v96, 16, v48
    v_and_b32 v97, 0xffff0000, v48
    v_lshlrev_b32 v98, 16, v49
    v_and_b32 v99, 0xffff0000, v49
    v_lshlrev_b32 v100, 16, v50
    v_and_b32 v101, 0xffff0000, v50
    v_lshlrev_b32 v102, 16, v51
    v_and_b32 v103, 0xffff0000, v51
    v_pk_add_f32 v[96:97], v[96:97], v[24:25]
    v_pk_add_f32 v[98:99], v[98:99], v[26:27]
    v_pk_add_f32 v[100:101], v[100:101], v[28:29]
    v_pk_add_f32 v[102:103], v[102:103], v[30:31]
    v_cvt_pk_bf16_f32 v48, v96, v97
    v_cvt_pk_bf16_f32 v49, v98, v99
    v_cvt_pk_bf16_f32 v50, v100, v101
    v_cvt_pk_bf16_f32 v51, v102, v103
    buffer_store_dwordx4 v[48:51], v5, s[8:11], s74 offen offset:0
    v_cvt_pk_bf16_f32 v52, v104, v105
    v_cvt_pk_bf16_f32 v53, v106, v107
    v_cvt_pk_bf16_f32 v54, v108, v109
    v_cvt_pk_bf16_f32 v55, v110, v111
    v_lshlrev_b32 v104, 16, v52
    v_and_b32 v105, 0xffff0000, v52
    v_lshlrev_b32 v106, 16, v53
    v_and_b32 v107, 0xffff0000, v53
    v_lshlrev_b32 v108, 16, v54
    v_and_b32 v109, 0xffff0000, v54
    v_lshlrev_b32 v110, 16, v55
    v_and_b32 v111, 0xffff0000, v55
    v_pk_add_f32 v[104:105], v[104:105], v[32:33]
    v_pk_add_f32 v[106:107], v[106:107], v[34:35]
    v_pk_add_f32 v[108:109], v[108:109], v[36:37]
    v_pk_add_f32 v[110:111], v[110:111], v[38:39]
    v_cvt_pk_bf16_f32 v52, v104, v105
    v_cvt_pk_bf16_f32 v53, v106, v107
    v_cvt_pk_bf16_f32 v54, v108, v109
    v_cvt_pk_bf16_f32 v55, v110, v111
    buffer_store_dwordx4 v[52:55], v5, s[8:11], s74 offen offset:16
L4_e:
L_end:
    s_endpgm
L_stop:
.section .rodata,"a"
.p2align 6
.amdhsa_kernel sequential_preLN__ssm_conv_s4d__glu_gated_glu__prompt_kernel
  .amdhsa_next_free_vgpr 256
  .amdhsa_next_free_sgpr 102
  .amdhsa_accum_offset 256
  .amdhsa_group_segment_fixed_size 0
  .amdhsa_kernarg_size 112
  .amdhsa_user_sgpr_count 2
  .amdhsa_user_sgpr_kernarg_segment_ptr 1
  .amdhsa_system_sgpr_workgroup_id_x 1
  .amdhsa_float_denorm_mode_32 3
.end_amdhsa_kernel
```
